```python
import torch

def _softmax(x, axis=-1):
    return torch.softmax(x, dim=axis)
def _gelu(x):
    return torch.nn.functional.gelu(x, approximate="tanh")
def _silu(x):
    return torch.nn.functional.silu(x)
def _sigmoid(x):
    return torch.sigmoid(x)
def _layernorm(x, axis=-1, eps=1e-5):
    m = x.mean(dim=axis, keepdim=True)
    v = x.var(dim=axis, keepdim=True, unbiased=False)
    return (x - m) / torch.sqrt(v + eps)
def _scatter_add(tgt, idx, src, axis=0):
    return tgt.clone().index_add_(axis, idx, src)
def _segment_sum(src, seg, n):
    out = torch.zeros((n,) + src.shape[1:], dtype=src.dtype)
    return out.index_add_(0, seg, src)
def _pad(x, pw):
    flat = tuple(v for pair in reversed(pw) for v in pair)
    return torch.nn.functional.pad(x, flat)

kernel_name = 'sequential_preLN__sliding_local_dilated__glu_gated_geglu__prompt'

def setup_inputs():

    _w = (lambda a: (lambda t: t.to(torch.bfloat16) if t.is_floating_point() else t)(torch.as_tensor(a)))
    def _A_setup():
        B, S, D = 1, 2048, 512
        return {
            "x": _w((lambda *s: torch.randn(*s, dtype=torch.bfloat16) * 0.05)(B, S, D)),
            "wqkv": _w((lambda *s: torch.randn(*s, dtype=torch.bfloat16) * 0.05)(D, 3 * D)),
            "wo": _w((lambda *s: torch.randn(*s, dtype=torch.bfloat16) * 0.05)(D, D)),
        }
    _A_in = _A_setup()

    def _B_setup():
        B, S, Dm, Df = 1, 2048, 512, 1792
        return {
            "x": _w((lambda *s: torch.randn(*s, dtype=torch.bfloat16) * 0.05)(B, S, Dm)),
            "w_gate": _w((lambda *s: torch.randn(*s, dtype=torch.bfloat16) * 0.8)(Dm, Df) * (Dm ** -0.5)),
            "w_up": _w((lambda *s: torch.randn(*s, dtype=torch.bfloat16) * 0.8)(Dm, Df) * (Dm ** -0.5)),
            "w_down": _w((lambda *s: torch.randn(*s, dtype=torch.bfloat16) * 0.8)(Df, Dm) * (Df ** -0.5)),
        }
    _B_in = _B_setup()

    return {
        "A_x": _A_in["x"],
        "A_wqkv": _A_in["wqkv"],
        "A_wo": _A_in["wo"],
        "B_x": _B_in["x"],
        "B_w_gate": _B_in["w_gate"],
        "B_w_up": _B_in["w_up"],
        "B_w_down": _B_in["w_down"],
    }

def reference(A_x, A_wqkv, A_wo, B_x, B_w_gate, B_w_up, B_w_down):
    def _A_ref(x, wqkv, wo):
        B, S, D = x.shape
        H = 32; Dh = D // H
        W, dil = 8, 2
        qkv = (lambda x, *d: x.permute(*d))((x @ wqkv).reshape(B, S, 3, H, Dh), 2, 0, 3, 1, 4)
        q, k, v = qkv[0], qkv[1], qkv[2]
        scale = Dh ** -0.5
        pos = torch.arange(S)
        off = torch.arange(W) * dil
        idx = pos[:, None] - off[None, :]
        mask = idx >= 0
        idx_c = torch.where(mask, idx, 0).reshape(-1)
        kg = k[:, :, idx_c, :].reshape(B, H, S, W, Dh)
        vg = v[:, :, idx_c, :].reshape(B, H, S, W, Dh)
        logits = torch.einsum("bhsd,bhswd->bhsw", q, kg) * scale
        logits = torch.where(mask[None, None, :, :], logits, -1e9)
        attn = _softmax(logits, axis=-1)
        o = torch.einsum("bhsw,bhswd->bhsd", attn, vg)
        return (lambda x, *d: x.permute(*d))(o, 0, 2, 1, 3).reshape(B, S, D) @ wo

    def _B_ref(x, w_gate, w_up, w_down):
        g = torch.einsum("bsd,df->bsf", x, w_gate)
        u = torch.einsum("bsd,df->bsf", x, w_up)
        h = _gelu(g) * u
        return torch.einsum("bsf,fd->bsd", h, w_down)

    x = A_x
    h = x + _A_ref(_layernorm(x, axis=-1), A_wqkv, A_wo)
    h2 = h + _B_ref(_layernorm(h, axis=-1), B_w_gate, B_w_up, B_w_down)
    return h2
```

```asm
; @launch grid=(256,1,1) block=(512,1,1) lds=163840
.amdgcn_target "amdgcn-amd-amdhsa--gfx950"
.text
.globl sequential_preLN__sliding_local_dilated__glu_gated_geglu__prompt_kernel
.p2align 8
.type sequential_preLN__sliding_local_dilated__glu_gated_geglu__prompt_kernel,@function
sequential_preLN__sliding_local_dilated__glu_gated_geglu__prompt_kernel:
  s_cmp_ge_u32 s2, 256
  s_cbranch_scc1 sequential_preLN__sliding_local_dilated__glu_gated_geglu__prompt_kernel_end
  s_getpc_b64 s[24:25]
sequential_preLN__sliding_local_dilated__glu_gated_geglu__prompt_kernel_pc:
  s_sub_u32 s24, s24, sequential_preLN__sliding_local_dilated__glu_gated_geglu__prompt_kernel_pc-sequential_preLN__sliding_local_dilated__glu_gated_geglu__prompt_kernel
  s_subb_u32 s25, s25, 0
  s_mov_b32 s26, code_end-sequential_preLN__sliding_local_dilated__glu_gated_geglu__prompt_kernel
  s_mov_b32 s27, 0x00020000
  v_lshlrev_b32 v3, 7, v0
  buffer_load_dword v255, v3, s[24:27], 0 offen
  s_memrealtime s[54:55]
  s_load_dwordx4 s[44:47], s[0:1], 0
  s_load_dwordx2 s[4:5], s[0:1], 72
  s_load_dwordx2 s[6:7], s[0:1], 16
  s_load_dwordx4 s[20:23], s[0:1], 32
  v_lshrrev_b32 v2, 6, v0
  v_and_b32 v1, 63, v0
  v_readfirstlane_b32 s28, v2
  s_and_b32 s3, s2, 7
  s_lshr_b32 s31, s2, 3
  s_lshr_b32 s29, s3, 1
  s_lshl_b32 s29, s29, 3
  s_lshr_b32 s30, s31, 2
  s_add_u32 s29, s29, s30
  s_and_b32 s30, s3, 1
  s_lshl_b32 s30, s30, 2
  s_and_b32 s31, s31, 3
  s_add_u32 s30, s30, s31
  s_lshr_b32 s3, s2, 5
  s_lshl_b32 s40, s31, 1
  s_add_u32 s40, s40, s3
  s_and_b32 s40, s40, 7
  s_waitcnt lgkmcnt(0)
  s_cmp_ge_u32 s28, 4
  s_cbranch_scc0 sequential_preLN__sliding_local_dilated__glu_gated_geglu__prompt_kernel_compute
sequential_preLN__sliding_local_dilated__glu_gated_geglu__prompt_kernel_loader:
  s_and_b32 s31, s28, 1
  s_lshl_b32 s3, s31, 2
  v_and_b32 v2, 15, v1
  v_lshrrev_b32 v3, 4, v1
  v_lshrrev_b32 v9, 1, v2
  v_xor_b32 v9, v9, v3
  v_xor_b32 v9, s3, v9
  v_lshlrev_b32 v2, 7, v2
  v_lshl_add_u32 v10, v9, 4, v2
  v_add_u32 v11, 69632, v10
  v_mov_b32 v12, 0x3f803f80
  v_mov_b32 v13, 0x3f803f80
  v_mov_b32 v14, 0x3f803f80
  v_mov_b32 v15, 0x3f803f80
  s_cmp_ge_u32 s28, 6
  s_cbranch_scc0 sequential_preLN__sliding_local_dilated__glu_gated_geglu__prompt_kernel_loada
sequential_preLN__sliding_local_dilated__glu_gated_geglu__prompt_kernel_loadw:
  s_mov_b32 s12, s46
  s_mov_b32 s13, s47
  s_mov_b32 s14, 0x180000
  s_mov_b32 s15, 0x00020000
  v_lshrrev_b32 v2, 3, v1
  v_mul_u32_u24 v4, 3072, v2
  v_and_b32 v2, 1, v1
  v_lshl_add_u32 v4, v2, 4, v4
  s_lshl_b32 s3, s30, 7
  v_add_u32 v4, s3, v4
  v_bfe_u32 v2, v1, 1, 2
  v_bfe_u32 v3, v1, 4, 1
  v_xor_b32 v2, v2, v3
  v_xor_b32 v3, 2, v2
  v_lshl_add_u32 v5, v3, 5, v4
  v_lshl_add_u32 v4, v2, 5, v4
  s_mul_i32 s35, s31, 12288
  s_add_u32 s35, s35, 10240
  s_cmp_eq_u32 s31, 0
  s_mov_b32 s82, 99328
  s_cmov_b32 s82, 0
  s_cmp_eq_u32 s31, 0
  s_mov_b32 s83, 123904
  s_cmov_b32 s83, 24576
  s_cmp_eq_u32 s31, 0
  s_mov_b32 s84, 148480
  s_cmov_b32 s84, 49152
  s_cmp_eq_u32 s31, 0
  s_mov_b32 s85, 173056
  s_cmov_b32 s85, 73728
  s_cmp_eq_u32 s31, 0
  s_mov_b32 s86, 2048
  s_cmov_b32 s86, 98304
  s_cmp_eq_u32 s31, 0
  s_mov_b32 s87, 26624
  s_cmov_b32 s87, 122880
  s_cmp_eq_u32 s31, 0
  s_mov_b32 s88, 51200
  s_cmov_b32 s88, 147456
  s_cmp_eq_u32 s31, 0
  s_mov_b32 s89, 75776
  s_cmov_b32 s89, 172032
  s_cmp_eq_u32 s31, 0
  s_mov_b32 s90, 100352
  s_cmov_b32 s90, 1024
  s_cmp_eq_u32 s31, 0
  s_mov_b32 s91, 124928
  s_cmov_b32 s91, 25600
  s_cmp_eq_u32 s31, 0
  s_mov_b32 s92, 149504
  s_cmov_b32 s92, 50176
  s_cmp_eq_u32 s31, 0
  s_mov_b32 s93, 174080
  s_cmov_b32 s93, 74752
  s_mul_i32 s41, s40, 196608
  s_add_u32 s40, s40, 1
  s_and_b32 s40, s40, 7
  s_add_u32 m0, s35, 0
  s_add_u32 s34, s82, s41
  buffer_load_dwordx4 v4, s[12:15], s34 offen lds
  s_add_u32 m0, s35, 1024
  s_add_u32 s34, s83, s41
  buffer_load_dwordx4 v5, s[12:15], s34 offen lds
  s_add_u32 m0, s35, 2048
  s_add_u32 s34, s84, s41
  buffer_load_dwordx4 v4, s[12:15], s34 offen lds
  s_add_u32 m0, s35, 3072
  s_add_u32 s34, s85, s41
  buffer_load_dwordx4 v5, s[12:15], s34 offen lds
  s_add_u32 m0, s35, 4096
  s_add_u32 s34, s86, s41
  buffer_load_dwordx4 v4, s[12:15], s34 offen lds
  s_add_u32 m0, s35, 5120
  s_add_u32 s34, s87, s41
  buffer_load_dwordx4 v5, s[12:15], s34 offen lds
  s_add_u32 m0, s35, 6144
  s_add_u32 s34, s88, s41
  buffer_load_dwordx4 v4, s[12:15], s34 offen lds
  s_add_u32 m0, s35, 7168
  s_add_u32 s34, s89, s41
  buffer_load_dwordx4 v5, s[12:15], s34 offen lds
  s_add_u32 m0, s35, 8192
  s_add_u32 s34, s90, s41
  buffer_load_dwordx4 v4, s[12:15], s34 offen lds
  s_add_u32 m0, s35, 9216
  s_add_u32 s34, s91, s41
  buffer_load_dwordx4 v5, s[12:15], s34 offen lds
  s_add_u32 m0, s35, 10240
  s_add_u32 s34, s92, s41
  buffer_load_dwordx4 v4, s[12:15], s34 offen lds
  s_add_u32 m0, s35, 11264
  s_add_u32 s34, s93, s41
  buffer_load_dwordx4 v5, s[12:15], s34 offen lds
  s_mul_i32 s41, s40, 196608
  s_add_u32 s40, s40, 1
  s_and_b32 s40, s40, 7
  s_add_u32 m0, s35, 34816
  s_add_u32 s34, s82, s41
  buffer_load_dwordx4 v4, s[12:15], s34 offen lds
  s_add_u32 m0, s35, 35840
  s_add_u32 s34, s83, s41
  buffer_load_dwordx4 v5, s[12:15], s34 offen lds
  s_add_u32 m0, s35, 36864
  s_add_u32 s34, s84, s41
  buffer_load_dwordx4 v4, s[12:15], s34 offen lds
  s_add_u32 m0, s35, 37888
  s_add_u32 s34, s85, s41
  buffer_load_dwordx4 v5, s[12:15], s34 offen lds
  s_add_u32 m0, s35, 38912
  s_add_u32 s34, s86, s41
  buffer_load_dwordx4 v4, s[12:15], s34 offen lds
  s_add_u32 m0, s35, 39936
  s_add_u32 s34, s87, s41
  buffer_load_dwordx4 v5, s[12:15], s34 offen lds
  s_add_u32 m0, s35, 40960
  s_add_u32 s34, s88, s41
  buffer_load_dwordx4 v4, s[12:15], s34 offen lds
  s_add_u32 m0, s35, 41984
  s_add_u32 s34, s89, s41
  buffer_load_dwordx4 v5, s[12:15], s34 offen lds
  s_add_u32 m0, s35, 43008
  s_add_u32 s34, s90, s41
  buffer_load_dwordx4 v4, s[12:15], s34 offen lds
  s_add_u32 m0, s35, 44032
  s_add_u32 s34, s91, s41
  buffer_load_dwordx4 v5, s[12:15], s34 offen lds
  s_add_u32 m0, s35, 45056
  s_add_u32 s34, s92, s41
  buffer_load_dwordx4 v4, s[12:15], s34 offen lds
  s_add_u32 m0, s35, 46080
  s_add_u32 s34, s93, s41
  buffer_load_dwordx4 v5, s[12:15], s34 offen lds
  s_waitcnt vmcnt(12)
  s_barrier
  ds_read_b128 v[16:19], v10 offset:6144
  ds_read_b128 v[20:23], v10 offset:8192
  s_waitcnt lgkmcnt(1)
  v_mfma_f32_16x16x32_bf16 v[28:31], v[16:19], v[16:19], 0
  v_mfma_f32_16x16x32_bf16 v[40:43], v[16:19], v[12:15], 0
  s_waitcnt lgkmcnt(0)
  v_mfma_f32_16x16x32_bf16 v[32:35], v[20:23], v[20:23], 0
  v_mfma_f32_16x16x32_bf16 v[44:47], v[20:23], v[12:15], 0
  s_mul_i32 s41, s40, 196608
  s_add_u32 s40, s40, 1
  s_and_b32 s40, s40, 7
  s_add_u32 m0, s35, 69632
  s_add_u32 s34, s82, s41
  buffer_load_dwordx4 v4, s[12:15], s34 offen lds
  s_add_u32 m0, s35, 70656
  s_add_u32 s34, s83, s41
  buffer_load_dwordx4 v5, s[12:15], s34 offen lds
  s_add_u32 m0, s35, 71680
  s_add_u32 s34, s84, s41
  buffer_load_dwordx4 v4, s[12:15], s34 offen lds
  s_add_u32 m0, s35, 72704
  s_add_u32 s34, s85, s41
  buffer_load_dwordx4 v5, s[12:15], s34 offen lds
  s_add_u32 m0, s35, 73728
  s_add_u32 s34, s86, s41
  buffer_load_dwordx4 v4, s[12:15], s34 offen lds
  s_add_u32 m0, s35, 74752
  s_add_u32 s34, s87, s41
  buffer_load_dwordx4 v5, s[12:15], s34 offen lds
  s_add_u32 m0, s35, 75776
  s_add_u32 s34, s88, s41
  buffer_load_dwordx4 v4, s[12:15], s34 offen lds
  s_add_u32 m0, s35, 76800
  s_add_u32 s34, s89, s41
  buffer_load_dwordx4 v5, s[12:15], s34 offen lds
  s_add_u32 m0, s35, 77824
  s_add_u32 s34, s90, s41
  buffer_load_dwordx4 v4, s[12:15], s34 offen lds
  s_add_u32 m0, s35, 78848
  s_add_u32 s34, s91, s41
  buffer_load_dwordx4 v5, s[12:15], s34 offen lds
  s_add_u32 m0, s35, 79872
  s_add_u32 s34, s92, s41
  buffer_load_dwordx4 v4, s[12:15], s34 offen lds
  s_add_u32 m0, s35, 80896
  s_add_u32 s34, s93, s41
  buffer_load_dwordx4 v5, s[12:15], s34 offen lds
  s_waitcnt vmcnt(12)
  s_barrier
  ds_read_b128 v[16:19], v10 offset:40960
  ds_read_b128 v[20:23], v10 offset:43008
  s_waitcnt lgkmcnt(1)
  v_mfma_f32_16x16x32_bf16 v[28:31], v[16:19], v[16:19], v[28:31]
  v_mfma_f32_16x16x32_bf16 v[40:43], v[16:19], v[12:15], v[40:43]
  s_waitcnt lgkmcnt(0)
  v_mfma_f32_16x16x32_bf16 v[32:35], v[20:23], v[20:23], v[32:35]
  v_mfma_f32_16x16x32_bf16 v[44:47], v[20:23], v[12:15], v[44:47]
  s_mul_i32 s41, s40, 196608
  s_add_u32 s40, s40, 1
  s_and_b32 s40, s40, 7
  s_add_u32 m0, s35, 104448
  s_add_u32 s34, s82, s41
  buffer_load_dwordx4 v4, s[12:15], s34 offen lds
  s_add_u32 m0, s35, 105472
  s_add_u32 s34, s83, s41
  buffer_load_dwordx4 v5, s[12:15], s34 offen lds
  s_add_u32 m0, s35, 106496
  s_add_u32 s34, s84, s41
  buffer_load_dwordx4 v4, s[12:15], s34 offen lds
  s_add_u32 m0, s35, 107520
  s_add_u32 s34, s85, s41
  buffer_load_dwordx4 v5, s[12:15], s34 offen lds
  s_add_u32 m0, s35, 108544
  s_add_u32 s34, s86, s41
  buffer_load_dwordx4 v4, s[12:15], s34 offen lds
  s_add_u32 m0, s35, 109568
  s_add_u32 s34, s87, s41
  buffer_load_dwordx4 v5, s[12:15], s34 offen lds
  s_add_u32 m0, s35, 110592
  s_add_u32 s34, s88, s41
  buffer_load_dwordx4 v4, s[12:15], s34 offen lds
  s_add_u32 m0, s35, 111616
  s_add_u32 s34, s89, s41
  buffer_load_dwordx4 v5, s[12:15], s34 offen lds
  s_add_u32 m0, s35, 112640
  s_add_u32 s34, s90, s41
  buffer_load_dwordx4 v4, s[12:15], s34 offen lds
  s_add_u32 m0, s35, 113664
  s_add_u32 s34, s91, s41
  buffer_load_dwordx4 v5, s[12:15], s34 offen lds
  s_add_u32 m0, s35, 114688
  s_add_u32 s34, s92, s41
  buffer_load_dwordx4 v4, s[12:15], s34 offen lds
  s_add_u32 m0, s35, 115712
  s_add_u32 s34, s93, s41
  buffer_load_dwordx4 v5, s[12:15], s34 offen lds
  s_waitcnt vmcnt(12)
  s_barrier
  ds_read_b128 v[16:19], v11 offset:6144
  ds_read_b128 v[20:23], v11 offset:8192
  s_waitcnt lgkmcnt(1)
  v_mfma_f32_16x16x32_bf16 v[28:31], v[16:19], v[16:19], v[28:31]
  v_mfma_f32_16x16x32_bf16 v[40:43], v[16:19], v[12:15], v[40:43]
  s_waitcnt lgkmcnt(0)
  v_mfma_f32_16x16x32_bf16 v[32:35], v[20:23], v[20:23], v[32:35]
  v_mfma_f32_16x16x32_bf16 v[44:47], v[20:23], v[12:15], v[44:47]
  s_mul_i32 s41, s40, 196608
  s_add_u32 s40, s40, 1
  s_and_b32 s40, s40, 7
  s_add_u32 m0, s35, 0
  s_add_u32 s34, s82, s41
  buffer_load_dwordx4 v4, s[12:15], s34 offen lds
  s_add_u32 m0, s35, 1024
  s_add_u32 s34, s83, s41
  buffer_load_dwordx4 v5, s[12:15], s34 offen lds
  s_add_u32 m0, s35, 2048
  s_add_u32 s34, s84, s41
  buffer_load_dwordx4 v4, s[12:15], s34 offen lds
  s_add_u32 m0, s35, 3072
  s_add_u32 s34, s85, s41
  buffer_load_dwordx4 v5, s[12:15], s34 offen lds
  s_add_u32 m0, s35, 4096
  s_add_u32 s34, s86, s41
  buffer_load_dwordx4 v4, s[12:15], s34 offen lds
  s_add_u32 m0, s35, 5120
  s_add_u32 s34, s87, s41
  buffer_load_dwordx4 v5, s[12:15], s34 offen lds
  s_add_u32 m0, s35, 6144
  s_add_u32 s34, s88, s41
  buffer_load_dwordx4 v4, s[12:15], s34 offen lds
  s_add_u32 m0, s35, 7168
  s_add_u32 s34, s89, s41
  buffer_load_dwordx4 v5, s[12:15], s34 offen lds
  s_add_u32 m0, s35, 8192
  s_add_u32 s34, s90, s41
  buffer_load_dwordx4 v4, s[12:15], s34 offen lds
  s_add_u32 m0, s35, 9216
  s_add_u32 s34, s91, s41
  buffer_load_dwordx4 v5, s[12:15], s34 offen lds
  s_add_u32 m0, s35, 10240
  s_add_u32 s34, s92, s41
  buffer_load_dwordx4 v4, s[12:15], s34 offen lds
  s_add_u32 m0, s35, 11264
  s_add_u32 s34, s93, s41
  buffer_load_dwordx4 v5, s[12:15], s34 offen lds
  s_waitcnt vmcnt(12)
  s_barrier
  ds_read_b128 v[16:19], v11 offset:40960
  ds_read_b128 v[20:23], v11 offset:43008
  s_waitcnt lgkmcnt(1)
  v_mfma_f32_16x16x32_bf16 v[28:31], v[16:19], v[16:19], v[28:31]
  v_mfma_f32_16x16x32_bf16 v[40:43], v[16:19], v[12:15], v[40:43]
  s_waitcnt lgkmcnt(0)
  v_mfma_f32_16x16x32_bf16 v[32:35], v[20:23], v[20:23], v[32:35]
  v_mfma_f32_16x16x32_bf16 v[44:47], v[20:23], v[12:15], v[44:47]
  s_mul_i32 s41, s40, 196608
  s_add_u32 s40, s40, 1
  s_and_b32 s40, s40, 7
  s_add_u32 m0, s35, 34816
  s_add_u32 s34, s82, s41
  buffer_load_dwordx4 v4, s[12:15], s34 offen lds
  s_add_u32 m0, s35, 35840
  s_add_u32 s34, s83, s41
  buffer_load_dwordx4 v5, s[12:15], s34 offen lds
  s_add_u32 m0, s35, 36864
  s_add_u32 s34, s84, s41
  buffer_load_dwordx4 v4, s[12:15], s34 offen lds
  s_add_u32 m0, s35, 37888
  s_add_u32 s34, s85, s41
  buffer_load_dwordx4 v5, s[12:15], s34 offen lds
  s_add_u32 m0, s35, 38912
  s_add_u32 s34, s86, s41
  buffer_load_dwordx4 v4, s[12:15], s34 offen lds
  s_add_u32 m0, s35, 39936
  s_add_u32 s34, s87, s41
  buffer_load_dwordx4 v5, s[12:15], s34 offen lds
  s_add_u32 m0, s35, 40960
  s_add_u32 s34, s88, s41
  buffer_load_dwordx4 v4, s[12:15], s34 offen lds
  s_add_u32 m0, s35, 41984
  s_add_u32 s34, s89, s41
  buffer_load_dwordx4 v5, s[12:15], s34 offen lds
  s_add_u32 m0, s35, 43008
  s_add_u32 s34, s90, s41
  buffer_load_dwordx4 v4, s[12:15], s34 offen lds
  s_add_u32 m0, s35, 44032
  s_add_u32 s34, s91, s41
  buffer_load_dwordx4 v5, s[12:15], s34 offen lds
  s_add_u32 m0, s35, 45056
  s_add_u32 s34, s92, s41
  buffer_load_dwordx4 v4, s[12:15], s34 offen lds
  s_add_u32 m0, s35, 46080
  s_add_u32 s34, s93, s41
  buffer_load_dwordx4 v5, s[12:15], s34 offen lds
  s_waitcnt vmcnt(12)
  s_barrier
  ds_read_b128 v[16:19], v10 offset:6144
  ds_read_b128 v[20:23], v10 offset:8192
  s_waitcnt lgkmcnt(1)
  v_mfma_f32_16x16x32_bf16 v[28:31], v[16:19], v[16:19], v[28:31]
  v_mfma_f32_16x16x32_bf16 v[40:43], v[16:19], v[12:15], v[40:43]
  s_waitcnt lgkmcnt(0)
  v_mfma_f32_16x16x32_bf16 v[32:35], v[20:23], v[20:23], v[32:35]
  v_mfma_f32_16x16x32_bf16 v[44:47], v[20:23], v[12:15], v[44:47]
  s_mul_i32 s41, s40, 196608
  s_add_u32 s40, s40, 1
  s_and_b32 s40, s40, 7
  s_add_u32 m0, s35, 69632
  s_add_u32 s34, s82, s41
  buffer_load_dwordx4 v4, s[12:15], s34 offen lds
  s_add_u32 m0, s35, 70656
  s_add_u32 s34, s83, s41
  buffer_load_dwordx4 v5, s[12:15], s34 offen lds
  s_add_u32 m0, s35, 71680
  s_add_u32 s34, s84, s41
  buffer_load_dwordx4 v4, s[12:15], s34 offen lds
  s_add_u32 m0, s35, 72704
  s_add_u32 s34, s85, s41
  buffer_load_dwordx4 v5, s[12:15], s34 offen lds
  s_add_u32 m0, s35, 73728
  s_add_u32 s34, s86, s41
  buffer_load_dwordx4 v4, s[12:15], s34 offen lds
  s_add_u32 m0, s35, 74752
  s_add_u32 s34, s87, s41
  buffer_load_dwordx4 v5, s[12:15], s34 offen lds
  s_add_u32 m0, s35, 75776
  s_add_u32 s34, s88, s41
  buffer_load_dwordx4 v4, s[12:15], s34 offen lds
  s_add_u32 m0, s35, 76800
  s_add_u32 s34, s89, s41
  buffer_load_dwordx4 v5, s[12:15], s34 offen lds
  s_add_u32 m0, s35, 77824
  s_add_u32 s34, s90, s41
  buffer_load_dwordx4 v4, s[12:15], s34 offen lds
  s_add_u32 m0, s35, 78848
  s_add_u32 s34, s91, s41
  buffer_load_dwordx4 v5, s[12:15], s34 offen lds
  s_add_u32 m0, s35, 79872
  s_add_u32 s34, s92, s41
  buffer_load_dwordx4 v4, s[12:15], s34 offen lds
  s_add_u32 m0, s35, 80896
  s_add_u32 s34, s93, s41
  buffer_load_dwordx4 v5, s[12:15], s34 offen lds
  s_waitcnt vmcnt(12)
  s_barrier
  ds_read_b128 v[16:19], v10 offset:40960
  ds_read_b128 v[20:23], v10 offset:43008
  s_waitcnt lgkmcnt(1)
  v_mfma_f32_16x16x32_bf16 v[28:31], v[16:19], v[16:19], v[28:31]
  v_mfma_f32_16x16x32_bf16 v[40:43], v[16:19], v[12:15], v[40:43]
  s_waitcnt lgkmcnt(0)
  v_mfma_f32_16x16x32_bf16 v[32:35], v[20:23], v[20:23], v[32:35]
  v_mfma_f32_16x16x32_bf16 v[44:47], v[20:23], v[12:15], v[44:47]
  s_mul_i32 s41, s40, 196608
  s_add_u32 s40, s40, 1
  s_and_b32 s40, s40, 7
  s_add_u32 m0, s35, 104448
  s_add_u32 s34, s82, s41
  buffer_load_dwordx4 v4, s[12:15], s34 offen lds
  s_add_u32 m0, s35, 105472
  s_add_u32 s34, s83, s41
  buffer_load_dwordx4 v5, s[12:15], s34 offen lds
  s_add_u32 m0, s35, 106496
  s_add_u32 s34, s84, s41
  buffer_load_dwordx4 v4, s[12:15], s34 offen lds
  s_add_u32 m0, s35, 107520
  s_add_u32 s34, s85, s41
  buffer_load_dwordx4 v5, s[12:15], s34 offen lds
  s_add_u32 m0, s35, 108544
  s_add_u32 s34, s86, s41
  buffer_load_dwordx4 v4, s[12:15], s34 offen lds
  s_add_u32 m0, s35, 109568
  s_add_u32 s34, s87, s41
  buffer_load_dwordx4 v5, s[12:15], s34 offen lds
  s_add_u32 m0, s35, 110592
  s_add_u32 s34, s88, s41
  buffer_load_dwordx4 v4, s[12:15], s34 offen lds
  s_add_u32 m0, s35, 111616
  s_add_u32 s34, s89, s41
  buffer_load_dwordx4 v5, s[12:15], s34 offen lds
  s_add_u32 m0, s35, 112640
  s_add_u32 s34, s90, s41
  buffer_load_dwordx4 v4, s[12:15], s34 offen lds
  s_add_u32 m0, s35, 113664
  s_add_u32 s34, s91, s41
  buffer_load_dwordx4 v5, s[12:15], s34 offen lds
  s_add_u32 m0, s35, 114688
  s_add_u32 s34, s92, s41
  buffer_load_dwordx4 v4, s[12:15], s34 offen lds
  s_add_u32 m0, s35, 115712
  s_add_u32 s34, s93, s41
  buffer_load_dwordx4 v5, s[12:15], s34 offen lds
  s_waitcnt vmcnt(12)
  s_barrier
  ds_read_b128 v[16:19], v11 offset:6144
  ds_read_b128 v[20:23], v11 offset:8192
  s_waitcnt lgkmcnt(1)
  v_mfma_f32_16x16x32_bf16 v[28:31], v[16:19], v[16:19], v[28:31]
  v_mfma_f32_16x16x32_bf16 v[40:43], v[16:19], v[12:15], v[40:43]
  s_waitcnt lgkmcnt(0)
  v_mfma_f32_16x16x32_bf16 v[32:35], v[20:23], v[20:23], v[32:35]
  v_mfma_f32_16x16x32_bf16 v[44:47], v[20:23], v[12:15], v[44:47]
  s_waitcnt vmcnt(0)
  s_barrier
  ds_read_b128 v[16:19], v11 offset:40960
  ds_read_b128 v[20:23], v11 offset:43008
  s_waitcnt lgkmcnt(1)
  v_mfma_f32_16x16x32_bf16 v[28:31], v[16:19], v[16:19], v[28:31]
  v_mfma_f32_16x16x32_bf16 v[40:43], v[16:19], v[12:15], v[40:43]
  s_waitcnt lgkmcnt(0)
  v_mfma_f32_16x16x32_bf16 v[32:35], v[20:23], v[20:23], v[32:35]
  v_mfma_f32_16x16x32_bf16 v[44:47], v[20:23], v[12:15], v[44:47]
  v_and_b32 v2, 3, v1
  v_cmp_eq_u32 s[48:49], 1, v2
  v_cmp_eq_u32 s[50:51], 2, v2
  v_cmp_eq_u32 s[52:53], 3, v2
  v_bfe_u32 v2, v1, 2, 2
  v_lshrrev_b32 v3, 4, v1
  v_cmp_eq_u32 vcc, v2, v3
  s_mul_i32 s3, s31, 1280
  s_add_u32 s3, s3, 139264
  v_and_b32 v2, 15, v1
  v_lshlrev_b32 v2, 2, v2
  v_add_u32 v2, s3, v2
  s_nop 3
  v_cndmask_b32_e64 v28, v28, v29, s[48:49]
  v_cndmask_b32_e64 v28, v28, v30, s[50:51]
  v_cndmask_b32_e64 v28, v28, v31, s[52:53]
  v_cndmask_b32_e64 v40, v40, v41, s[48:49]
  v_cndmask_b32_e64 v40, v40, v42, s[50:51]
  v_cndmask_b32_e64 v40, v40, v43, s[52:53]
  v_cndmask_b32_e64 v32, v32, v33, s[48:49]
  v_cndmask_b32_e64 v32, v32, v34, s[50:51]
  v_cndmask_b32_e64 v32, v32, v35, s[52:53]
  v_cndmask_b32_e64 v44, v44, v45, s[48:49]
  v_cndmask_b32_e64 v44, v44, v46, s[50:51]
  v_cndmask_b32_e64 v44, v44, v47, s[52:53]
  s_and_saveexec_b64 s[38:39], vcc
  ds_write_b32 v2, v40 offset:192
  ds_write_b32 v2, v28 offset:512
  ds_write_b32 v2, v44 offset:256
  ds_write_b32 v2, v32 offset:576
  s_mov_b64 exec, s[38:39]
  s_waitcnt lgkmcnt(0)
  s_barrier
  s_barrier
  s_mov_b32 s12, s6
  s_mov_b32 s13, s7
  s_mov_b32 s14, 0x80000
  s_mov_b32 s15, 0x00020000
  v_lshrrev_b32 v2, 3, v1
  v_lshlrev_b32 v4, 10, v2
  v_and_b32 v2, 1, v1
  v_lshl_add_u32 v4, v2, 4, v4
  s_lshl_b32 s3, s30, 7
  v_add_u32 v4, s3, v4
  v_bfe_u32 v2, v1, 1, 2
  v_bfe_u32 v3, v1, 4, 1
  v_xor_b32 v2, v2, v3
  v_xor_b32 v3, 2, v2
  v_lshl_add_u32 v5, v3, 5, v4
  v_lshl_add_u32 v4, v2, 5, v4
  s_lshl_b32 s34, s31, 18
  s_lshl_b32 s35, s31, 16
  s_barrier
  s_barrier
  s_add_u32 m0, s35, 16384
  s_nop 0
  buffer_load_dwordx4 v4, s[12:15], s34 offen lds
  s_add_u32 s34, s34, 8192
  s_add_u32 m0, s35, 17408
  s_nop 0
  buffer_load_dwordx4 v5, s[12:15], s34 offen lds
  s_add_u32 s34, s34, 8192
  s_add_u32 m0, s35, 18432
  s_nop 0
  buffer_load_dwordx4 v4, s[12:15], s34 offen lds
  s_add_u32 s34, s34, 8192
  s_add_u32 m0, s35, 19456
  s_nop 0
  buffer_load_dwordx4 v5, s[12:15], s34 offen lds
  s_add_u32 s34, s34, 8192
  s_add_u32 m0, s35, 20480
  s_nop 0
  buffer_load_dwordx4 v4, s[12:15], s34 offen lds
  s_add_u32 s34, s34, 8192
  s_add_u32 m0, s35, 21504
  s_nop 0
  buffer_load_dwordx4 v5, s[12:15], s34 offen lds
  s_add_u32 s34, s34, 8192
  s_add_u32 m0, s35, 22528
  s_nop 0
  buffer_load_dwordx4 v4, s[12:15], s34 offen lds
  s_add_u32 s34, s34, 8192
  s_add_u32 m0, s35, 23552
  s_nop 0
  buffer_load_dwordx4 v5, s[12:15], s34 offen lds
  s_add_u32 s34, s34, 8192
  s_add_u32 m0, s35, 24576
  s_nop 0
  buffer_load_dwordx4 v4, s[12:15], s34 offen lds
  s_add_u32 s34, s34, 8192
  s_add_u32 m0, s35, 25600
  s_nop 0
  buffer_load_dwordx4 v5, s[12:15], s34 offen lds
  s_add_u32 s34, s34, 8192
  s_add_u32 m0, s35, 26624
  s_nop 0
  buffer_load_dwordx4 v4, s[12:15], s34 offen lds
  s_add_u32 s34, s34, 8192
  s_add_u32 m0, s35, 27648
  s_nop 0
  buffer_load_dwordx4 v5, s[12:15], s34 offen lds
  s_add_u32 s34, s34, 8192
  s_add_u32 m0, s35, 28672
  s_nop 0
  buffer_load_dwordx4 v4, s[12:15], s34 offen lds
  s_add_u32 s34, s34, 8192
  s_add_u32 m0, s35, 29696
  s_nop 0
  buffer_load_dwordx4 v5, s[12:15], s34 offen lds
  s_add_u32 s34, s34, 8192
  s_add_u32 m0, s35, 30720
  s_nop 0
  buffer_load_dwordx4 v4, s[12:15], s34 offen lds
  s_add_u32 s34, s34, 8192
  s_add_u32 m0, s35, 31744
  s_nop 0
  buffer_load_dwordx4 v5, s[12:15], s34 offen lds
  s_add_u32 s34, s34, 8192
  s_add_u32 m0, s35, 49152
  s_nop 0
  buffer_load_dwordx4 v4, s[12:15], s34 offen lds
  s_add_u32 s34, s34, 8192
  s_add_u32 m0, s35, 50176
  s_nop 0
  buffer_load_dwordx4 v5, s[12:15], s34 offen lds
  s_add_u32 s34, s34, 8192
  s_add_u32 m0, s35, 51200
  s_nop 0
  buffer_load_dwordx4 v4, s[12:15], s34 offen lds
  s_add_u32 s34, s34, 8192
  s_add_u32 m0, s35, 52224
  s_nop 0
  buffer_load_dwordx4 v5, s[12:15], s34 offen lds
  s_add_u32 s34, s34, 8192
  s_add_u32 m0, s35, 53248
  s_nop 0
  buffer_load_dwordx4 v4, s[12:15], s34 offen lds
  s_add_u32 s34, s34, 8192
  s_add_u32 m0, s35, 54272
  s_nop 0
  buffer_load_dwordx4 v5, s[12:15], s34 offen lds
  s_add_u32 s34, s34, 8192
  s_add_u32 m0, s35, 55296
  s_nop 0
  buffer_load_dwordx4 v4, s[12:15], s34 offen lds
  s_add_u32 s34, s34, 8192
  s_add_u32 m0, s35, 56320
  s_nop 0
  buffer_load_dwordx4 v5, s[12:15], s34 offen lds
  s_add_u32 s34, s34, 8192
  s_add_u32 m0, s35, 57344
  s_nop 0
  buffer_load_dwordx4 v4, s[12:15], s34 offen lds
  s_add_u32 s34, s34, 8192
  s_add_u32 m0, s35, 58368
  s_nop 0
  buffer_load_dwordx4 v5, s[12:15], s34 offen lds
  s_add_u32 s34, s34, 8192
  s_add_u32 m0, s35, 59392
  s_nop 0
  buffer_load_dwordx4 v4, s[12:15], s34 offen lds
  s_add_u32 s34, s34, 8192
  s_add_u32 m0, s35, 60416
  s_nop 0
  buffer_load_dwordx4 v5, s[12:15], s34 offen lds
  s_add_u32 s34, s34, 8192
  s_add_u32 m0, s35, 61440
  s_nop 0
  buffer_load_dwordx4 v4, s[12:15], s34 offen lds
  s_add_u32 s34, s34, 8192
  s_add_u32 m0, s35, 62464
  s_nop 0
  buffer_load_dwordx4 v5, s[12:15], s34 offen lds
  s_add_u32 s34, s34, 8192
  s_add_u32 m0, s35, 63488
  s_nop 0
  buffer_load_dwordx4 v4, s[12:15], s34 offen lds
  s_add_u32 s34, s34, 8192
  s_add_u32 m0, s35, 64512
  s_nop 0
  buffer_load_dwordx4 v5, s[12:15], s34 offen lds
  s_add_u32 s34, s34, 8192
  s_waitcnt vmcnt(0)
  s_barrier
  s_barrier
  s_barrier
  s_branch k3_kernel
  s_waitcnt vmcnt(0)
  s_branch sequential_preLN__sliding_local_dilated__glu_gated_geglu__prompt_kernel_end
sequential_preLN__sliding_local_dilated__glu_gated_geglu__prompt_kernel_loada:
  s_cmp_eq_u32 s28, 5
  s_cbranch_scc1 sequential_preLN__sliding_local_dilated__glu_gated_geglu__prompt_kernel_pref
  s_mov_b32 s8, s44
  s_mov_b32 s9, s45
  s_mov_b32 s10, 0x200000
  s_mov_b32 s11, 0x00020000
  s_lshl_b32 s3, s29, 6
  s_sub_u32 s3, s3, 16
  v_lshrrev_b32 v2, 3, v1
  v_add_u32 v2, s3, v2
  v_and_b32 v3, 7, v1
  v_lshrrev_b32 v9, 4, v1
  v_xor_b32 v3, v3, v9
  v_add_u32 v9, 0, v2
  v_max_i32 v9, 0, v9
  v_lshlrev_b32 v9, 10, v9
  v_lshl_add_u32 v56, v3, 4, v9
  v_add_u32 v9, 8, v2
  v_max_i32 v9, 0, v9
  v_lshlrev_b32 v9, 10, v9
  v_xor_b32 v57, 4, v3
  v_lshl_add_u32 v57, v57, 4, v9
  v_add_u32 v9, 16, v2
  v_max_i32 v9, 0, v9
  v_lshlrev_b32 v9, 10, v9
  v_lshl_add_u32 v58, v3, 4, v9
  v_add_u32 v9, 24, v2
  v_max_i32 v9, 0, v9
  v_lshlrev_b32 v9, 10, v9
  v_xor_b32 v59, 4, v3
  v_lshl_add_u32 v59, v59, 4, v9
  v_add_u32 v9, 32, v2
  v_max_i32 v9, 0, v9
  v_lshlrev_b32 v9, 10, v9
  v_lshl_add_u32 v60, v3, 4, v9
  v_add_u32 v9, 40, v2
  v_max_i32 v9, 0, v9
  v_lshlrev_b32 v9, 10, v9
  v_xor_b32 v61, 4, v3
  v_lshl_add_u32 v61, v61, 4, v9
  v_add_u32 v9, 48, v2
  v_max_i32 v9, 0, v9
  v_lshlrev_b32 v9, 10, v9
  v_lshl_add_u32 v62, v3, 4, v9
  v_add_u32 v9, 56, v2
  v_max_i32 v9, 0, v9
  v_lshlrev_b32 v9, 10, v9
  v_xor_b32 v63, 4, v3
  v_lshl_add_u32 v63, v63, 4, v9
  v_add_u32 v9, 64, v2
  v_max_i32 v9, 0, v9
  v_lshlrev_b32 v9, 10, v9
  v_lshl_add_u32 v64, v3, 4, v9
  v_add_u32 v9, 72, v2
  v_max_i32 v9, 0, v9
  v_lshlrev_b32 v9, 10, v9
  v_xor_b32 v65, 4, v3
  v_lshl_add_u32 v65, v65, 4, v9
  s_lshl_b32 s34, s40, 7
  s_add_u32 s40, s40, 1
  s_and_b32 s40, s40, 7
  s_mov_b32 m0, 0
  s_nop 0
  buffer_load_dwordx4 v56, s[8:11], s34 offen lds
  s_mov_b32 m0, 1024
  s_nop 0
  buffer_load_dwordx4 v57, s[8:11], s34 offen lds
  s_mov_b32 m0, 2048
  s_nop 0
  buffer_load_dwordx4 v58, s[8:11], s34 offen lds
  s_mov_b32 m0, 3072
  s_nop 0
  buffer_load_dwordx4 v59, s[8:11], s34 offen lds
  s_mov_b32 m0, 4096
  s_nop 0
  buffer_load_dwordx4 v60, s[8:11], s34 offen lds
  s_mov_b32 m0, 5120
  s_nop 0
  buffer_load_dwordx4 v61, s[8:11], s34 offen lds
  s_mov_b32 m0, 6144
  s_nop 0
  buffer_load_dwordx4 v62, s[8:11], s34 offen lds
  s_mov_b32 m0, 7168
  s_nop 0
  buffer_load_dwordx4 v63, s[8:11], s34 offen lds
  s_mov_b32 m0, 8192
  s_nop 0
  buffer_load_dwordx4 v64, s[8:11], s34 offen lds
  s_mov_b32 m0, 9216
  s_nop 0
  buffer_load_dwordx4 v65, s[8:11], s34 offen lds
  s_lshl_b32 s34, s40, 7
  s_add_u32 s40, s40, 1
  s_and_b32 s40, s40, 7
  s_mov_b32 m0, 34816
  s_nop 0
  buffer_load_dwordx4 v56, s[8:11], s34 offen lds
  s_mov_b32 m0, 35840
  s_nop 0
  buffer_load_dwordx4 v57, s[8:11], s34 offen lds
  s_mov_b32 m0, 36864
  s_nop 0
  buffer_load_dwordx4 v58, s[8:11], s34 offen lds
  s_mov_b32 m0, 37888
  s_nop 0
  buffer_load_dwordx4 v59, s[8:11], s34 offen lds
  s_mov_b32 m0, 38912
  s_nop 0
  buffer_load_dwordx4 v60, s[8:11], s34 offen lds
  s_mov_b32 m0, 39936
  s_nop 0
  buffer_load_dwordx4 v61, s[8:11], s34 offen lds
  s_mov_b32 m0, 40960
  s_nop 0
  buffer_load_dwordx4 v62, s[8:11], s34 offen lds
  s_mov_b32 m0, 41984
  s_nop 0
  buffer_load_dwordx4 v63, s[8:11], s34 offen lds
  s_mov_b32 m0, 43008
  s_nop 0
  buffer_load_dwordx4 v64, s[8:11], s34 offen lds
  s_mov_b32 m0, 44032
  s_nop 0
  buffer_load_dwordx4 v65, s[8:11], s34 offen lds
  s_waitcnt vmcnt(10)
  s_barrier
  s_lshl_b32 s34, s40, 7
  s_add_u32 s40, s40, 1
  s_and_b32 s40, s40, 7
  s_mov_b32 m0, 69632
  s_nop 0
  buffer_load_dwordx4 v56, s[8:11], s34 offen lds
  s_mov_b32 m0, 70656
  s_nop 0
  buffer_load_dwordx4 v57, s[8:11], s34 offen lds
  s_mov_b32 m0, 71680
  s_nop 0
  buffer_load_dwordx4 v58, s[8:11], s34 offen lds
  s_mov_b32 m0, 72704
  s_nop 0
  buffer_load_dwordx4 v59, s[8:11], s34 offen lds
  s_mov_b32 m0, 73728
  s_nop 0
  buffer_load_dwordx4 v60, s[8:11], s34 offen lds
  s_mov_b32 m0, 74752
  s_nop 0
  buffer_load_dwordx4 v61, s[8:11], s34 offen lds
  s_mov_b32 m0, 75776
  s_nop 0
  buffer_load_dwordx4 v62, s[8:11], s34 offen lds
  s_mov_b32 m0, 76800
  s_nop 0
  buffer_load_dwordx4 v63, s[8:11], s34 offen lds
  s_mov_b32 m0, 77824
  s_nop 0
  buffer_load_dwordx4 v64, s[8:11], s34 offen lds
  s_mov_b32 m0, 78848
  s_nop 0
  buffer_load_dwordx4 v65, s[8:11], s34 offen lds
  ds_read_b128 v[16:19], v10 offset:0
  ds_read_b128 v[20:23], v10 offset:2048
  ds_read_b128 v[24:27], v10 offset:4096
  s_waitcnt lgkmcnt(2)
  v_mfma_f32_16x16x32_bf16 v[28:31], v[16:19], v[16:19], 0
  v_mfma_f32_16x16x32_bf16 v[40:43], v[16:19], v[12:15], 0
  s_waitcnt lgkmcnt(1)
  v_mfma_f32_16x16x32_bf16 v[32:35], v[20:23], v[20:23], 0
  v_mfma_f32_16x16x32_bf16 v[44:47], v[20:23], v[12:15], 0
  s_waitcnt lgkmcnt(0)
  v_mfma_f32_16x16x32_bf16 v[36:39], v[24:27], v[24:27], 0
  v_mfma_f32_16x16x32_bf16 v[48:51], v[24:27], v[12:15], 0
  s_waitcnt vmcnt(10)
  s_barrier
  s_lshl_b32 s34, s40, 7
  s_add_u32 s40, s40, 1
  s_and_b32 s40, s40, 7
  s_mov_b32 m0, 104448
  s_nop 0
  buffer_load_dwordx4 v56, s[8:11], s34 offen lds
  s_mov_b32 m0, 105472
  s_nop 0
  buffer_load_dwordx4 v57, s[8:11], s34 offen lds
  s_mov_b32 m0, 106496
  s_nop 0
  buffer_load_dwordx4 v58, s[8:11], s34 offen lds
  s_mov_b32 m0, 107520
  s_nop 0
  buffer_load_dwordx4 v59, s[8:11], s34 offen lds
  s_mov_b32 m0, 108544
  s_nop 0
  buffer_load_dwordx4 v60, s[8:11], s34 offen lds
  s_mov_b32 m0, 109568
  s_nop 0
  buffer_load_dwordx4 v61, s[8:11], s34 offen lds
  s_mov_b32 m0, 110592
  s_nop 0
  buffer_load_dwordx4 v62, s[8:11], s34 offen lds
  s_mov_b32 m0, 111616
  s_nop 0
  buffer_load_dwordx4 v63, s[8:11], s34 offen lds
  s_mov_b32 m0, 112640
  s_nop 0
  buffer_load_dwordx4 v64, s[8:11], s34 offen lds
  s_mov_b32 m0, 113664
  s_nop 0
  buffer_load_dwordx4 v65, s[8:11], s34 offen lds
  ds_read_b128 v[16:19], v10 offset:34816
  ds_read_b128 v[20:23], v10 offset:36864
  ds_read_b128 v[24:27], v10 offset:38912
  s_waitcnt lgkmcnt(2)
  v_mfma_f32_16x16x32_bf16 v[28:31], v[16:19], v[16:19], v[28:31]
  v_mfma_f32_16x16x32_bf16 v[40:43], v[16:19], v[12:15], v[40:43]
  s_waitcnt lgkmcnt(1)
  v_mfma_f32_16x16x32_bf16 v[32:35], v[20:23], v[20:23], v[32:35]
  v_mfma_f32_16x16x32_bf16 v[44:47], v[20:23], v[12:15], v[44:47]
  s_waitcnt lgkmcnt(0)
  v_mfma_f32_16x16x32_bf16 v[36:39], v[24:27], v[24:27], v[36:39]
  v_mfma_f32_16x16x32_bf16 v[48:51], v[24:27], v[12:15], v[48:51]
  s_waitcnt vmcnt(10)
  s_barrier
  s_lshl_b32 s34, s40, 7
  s_add_u32 s40, s40, 1
  s_and_b32 s40, s40, 7
  s_mov_b32 m0, 0
  s_nop 0
  buffer_load_dwordx4 v56, s[8:11], s34 offen lds
  s_mov_b32 m0, 1024
  s_nop 0
  buffer_load_dwordx4 v57, s[8:11], s34 offen lds
  s_mov_b32 m0, 2048
  s_nop 0
  buffer_load_dwordx4 v58, s[8:11], s34 offen lds
  s_mov_b32 m0, 3072
  s_nop 0
  buffer_load_dwordx4 v59, s[8:11], s34 offen lds
  s_mov_b32 m0, 4096
  s_nop 0
  buffer_load_dwordx4 v60, s[8:11], s34 offen lds
  s_mov_b32 m0, 5120
  s_nop 0
  buffer_load_dwordx4 v61, s[8:11], s34 offen lds
  s_mov_b32 m0, 6144
  s_nop 0
  buffer_load_dwordx4 v62, s[8:11], s34 offen lds
  s_mov_b32 m0, 7168
  s_nop 0
  buffer_load_dwordx4 v63, s[8:11], s34 offen lds
  s_mov_b32 m0, 8192
  s_nop 0
  buffer_load_dwordx4 v64, s[8:11], s34 offen lds
  s_mov_b32 m0, 9216
  s_nop 0
  buffer_load_dwordx4 v65, s[8:11], s34 offen lds
  ds_read_b128 v[16:19], v11 offset:0
  ds_read_b128 v[20:23], v11 offset:2048
  ds_read_b128 v[24:27], v11 offset:4096
  s_waitcnt lgkmcnt(2)
  v_mfma_f32_16x16x32_bf16 v[28:31], v[16:19], v[16:19], v[28:31]
  v_mfma_f32_16x16x32_bf16 v[40:43], v[16:19], v[12:15], v[40:43]
  s_waitcnt lgkmcnt(1)
  v_mfma_f32_16x16x32_bf16 v[32:35], v[20:23], v[20:23], v[32:35]
  v_mfma_f32_16x16x32_bf16 v[44:47], v[20:23], v[12:15], v[44:47]
  s_waitcnt lgkmcnt(0)
  v_mfma_f32_16x16x32_bf16 v[36:39], v[24:27], v[24:27], v[36:39]
  v_mfma_f32_16x16x32_bf16 v[48:51], v[24:27], v[12:15], v[48:51]
  s_waitcnt vmcnt(10)
  s_barrier
  s_lshl_b32 s34, s40, 7
  s_add_u32 s40, s40, 1
  s_and_b32 s40, s40, 7
  s_mov_b32 m0, 34816
  s_nop 0
  buffer_load_dwordx4 v56, s[8:11], s34 offen lds
  s_mov_b32 m0, 35840
  s_nop 0
  buffer_load_dwordx4 v57, s[8:11], s34 offen lds
  s_mov_b32 m0, 36864
  s_nop 0
  buffer_load_dwordx4 v58, s[8:11], s34 offen lds
  s_mov_b32 m0, 37888
  s_nop 0
  buffer_load_dwordx4 v59, s[8:11], s34 offen lds
  s_mov_b32 m0, 38912
  s_nop 0
  buffer_load_dwordx4 v60, s[8:11], s34 offen lds
  s_mov_b32 m0, 39936
  s_nop 0
  buffer_load_dwordx4 v61, s[8:11], s34 offen lds
  s_mov_b32 m0, 40960
  s_nop 0
  buffer_load_dwordx4 v62, s[8:11], s34 offen lds
  s_mov_b32 m0, 41984
  s_nop 0
  buffer_load_dwordx4 v63, s[8:11], s34 offen lds
  s_mov_b32 m0, 43008
  s_nop 0
  buffer_load_dwordx4 v64, s[8:11], s34 offen lds
  s_mov_b32 m0, 44032
  s_nop 0
  buffer_load_dwordx4 v65, s[8:11], s34 offen lds
  ds_read_b128 v[16:19], v11 offset:34816
  ds_read_b128 v[20:23], v11 offset:36864
  ds_read_b128 v[24:27], v11 offset:38912
  s_waitcnt lgkmcnt(2)
  v_mfma_f32_16x16x32_bf16 v[28:31], v[16:19], v[16:19], v[28:31]
  v_mfma_f32_16x16x32_bf16 v[40:43], v[16:19], v[12:15], v[40:43]
  s_waitcnt lgkmcnt(1)
  v_mfma_f32_16x16x32_bf16 v[32:35], v[20:23], v[20:23], v[32:35]
  v_mfma_f32_16x16x32_bf16 v[44:47], v[20:23], v[12:15], v[44:47]
  s_waitcnt lgkmcnt(0)
  v_mfma_f32_16x16x32_bf16 v[36:39], v[24:27], v[24:27], v[36:39]
  v_mfma_f32_16x16x32_bf16 v[48:51], v[24:27], v[12:15], v[48:51]
  s_waitcnt vmcnt(10)
  s_barrier
  s_lshl_b32 s34, s40, 7
  s_add_u32 s40, s40, 1
  s_and_b32 s40, s40, 7
  s_mov_b32 m0, 69632
  s_nop 0
  buffer_load_dwordx4 v56, s[8:11], s34 offen lds
  s_mov_b32 m0, 70656
  s_nop 0
  buffer_load_dwordx4 v57, s[8:11], s34 offen lds
  s_mov_b32 m0, 71680
  s_nop 0
  buffer_load_dwordx4 v58, s[8:11], s34 offen lds
  s_mov_b32 m0, 72704
  s_nop 0
  buffer_load_dwordx4 v59, s[8:11], s34 offen lds
  s_mov_b32 m0, 73728
  s_nop 0
  buffer_load_dwordx4 v60, s[8:11], s34 offen lds
  s_mov_b32 m0, 74752
  s_nop 0
  buffer_load_dwordx4 v61, s[8:11], s34 offen lds
  s_mov_b32 m0, 75776
  s_nop 0
  buffer_load_dwordx4 v62, s[8:11], s34 offen lds
  s_mov_b32 m0, 76800
  s_nop 0
  buffer_load_dwordx4 v63, s[8:11], s34 offen lds
  s_mov_b32 m0, 77824
  s_nop 0
  buffer_load_dwordx4 v64, s[8:11], s34 offen lds
  s_mov_b32 m0, 78848
  s_nop 0
  buffer_load_dwordx4 v65, s[8:11], s34 offen lds
  ds_read_b128 v[16:19], v10 offset:0
  ds_read_b128 v[20:23], v10 offset:2048
  ds_read_b128 v[24:27], v10 offset:4096
  s_waitcnt lgkmcnt(2)
  v_mfma_f32_16x16x32_bf16 v[28:31], v[16:19], v[16:19], v[28:31]
  v_mfma_f32_16x16x32_bf16 v[40:43], v[16:19], v[12:15], v[40:43]
  s_waitcnt lgkmcnt(1)
  v_mfma_f32_16x16x32_bf16 v[32:35], v[20:23], v[20:23], v[32:35]
  v_mfma_f32_16x16x32_bf16 v[44:47], v[20:23], v[12:15], v[44:47]
  s_waitcnt lgkmcnt(0)
  v_mfma_f32_16x16x32_bf16 v[36:39], v[24:27], v[24:27], v[36:39]
  v_mfma_f32_16x16x32_bf16 v[48:51], v[24:27], v[12:15], v[48:51]
  s_waitcnt vmcnt(10)
  s_barrier
  s_lshl_b32 s34, s40, 7
  s_add_u32 s40, s40, 1
  s_and_b32 s40, s40, 7
  s_mov_b32 m0, 104448
  s_nop 0
  buffer_load_dwordx4 v56, s[8:11], s34 offen lds
  s_mov_b32 m0, 105472
  s_nop 0
  buffer_load_dwordx4 v57, s[8:11], s34 offen lds
  s_mov_b32 m0, 106496
  s_nop 0
  buffer_load_dwordx4 v58, s[8:11], s34 offen lds
  s_mov_b32 m0, 107520
  s_nop 0
  buffer_load_dwordx4 v59, s[8:11], s34 offen lds
  s_mov_b32 m0, 108544
  s_nop 0
  buffer_load_dwordx4 v60, s[8:11], s34 offen lds
  s_mov_b32 m0, 109568
  s_nop 0
  buffer_load_dwordx4 v61, s[8:11], s34 offen lds
  s_mov_b32 m0, 110592
  s_nop 0
  buffer_load_dwordx4 v62, s[8:11], s34 offen lds
  s_mov_b32 m0, 111616
  s_nop 0
  buffer_load_dwordx4 v63, s[8:11], s34 offen lds
  s_mov_b32 m0, 112640
  s_nop 0
  buffer_load_dwordx4 v64, s[8:11], s34 offen lds
  s_mov_b32 m0, 113664
  s_nop 0
  buffer_load_dwordx4 v65, s[8:11], s34 offen lds
  ds_read_b128 v[16:19], v10 offset:34816
  ds_read_b128 v[20:23], v10 offset:36864
  ds_read_b128 v[24:27], v10 offset:38912
  s_waitcnt lgkmcnt(2)
  v_mfma_f32_16x16x32_bf16 v[28:31], v[16:19], v[16:19], v[28:31]
  v_mfma_f32_16x16x32_bf16 v[40:43], v[16:19], v[12:15], v[40:43]
  s_waitcnt lgkmcnt(1)
  v_mfma_f32_16x16x32_bf16 v[32:35], v[20:23], v[20:23], v[32:35]
  v_mfma_f32_16x16x32_bf16 v[44:47], v[20:23], v[12:15], v[44:47]
  s_waitcnt lgkmcnt(0)
  v_mfma_f32_16x16x32_bf16 v[36:39], v[24:27], v[24:27], v[36:39]
  v_mfma_f32_16x16x32_bf16 v[48:51], v[24:27], v[12:15], v[48:51]
  s_waitcnt vmcnt(10)
  s_barrier
  ds_read_b128 v[16:19], v11 offset:0
  ds_read_b128 v[20:23], v11 offset:2048
  ds_read_b128 v[24:27], v11 offset:4096
  s_waitcnt lgkmcnt(2)
  v_mfma_f32_16x16x32_bf16 v[28:31], v[16:19], v[16:19], v[28:31]
  v_mfma_f32_16x16x32_bf16 v[40:43], v[16:19], v[12:15], v[40:43]
  s_waitcnt lgkmcnt(1)
  v_mfma_f32_16x16x32_bf16 v[32:35], v[20:23], v[20:23], v[32:35]
  v_mfma_f32_16x16x32_bf16 v[44:47], v[20:23], v[12:15], v[44:47]
  s_waitcnt lgkmcnt(0)
  v_mfma_f32_16x16x32_bf16 v[36:39], v[24:27], v[24:27], v[36:39]
  v_mfma_f32_16x16x32_bf16 v[48:51], v[24:27], v[12:15], v[48:51]
  s_waitcnt vmcnt(0)
  s_barrier
  ds_read_b128 v[16:19], v11 offset:34816
  ds_read_b128 v[20:23], v11 offset:36864
  ds_read_b128 v[24:27], v11 offset:38912
  s_waitcnt lgkmcnt(2)
  v_mfma_f32_16x16x32_bf16 v[28:31], v[16:19], v[16:19], v[28:31]
  v_mfma_f32_16x16x32_bf16 v[40:43], v[16:19], v[12:15], v[40:43]
  s_waitcnt lgkmcnt(1)
  v_mfma_f32_16x16x32_bf16 v[32:35], v[20:23], v[20:23], v[32:35]
  v_mfma_f32_16x16x32_bf16 v[44:47], v[20:23], v[12:15], v[44:47]
  s_waitcnt lgkmcnt(0)
  v_mfma_f32_16x16x32_bf16 v[36:39], v[24:27], v[24:27], v[36:39]
  v_mfma_f32_16x16x32_bf16 v[48:51], v[24:27], v[12:15], v[48:51]
  v_and_b32 v2, 3, v1
  v_cmp_eq_u32 s[48:49], 1, v2
  v_cmp_eq_u32 s[50:51], 2, v2
  v_cmp_eq_u32 s[52:53], 3, v2
  v_bfe_u32 v2, v1, 2, 2
  v_lshrrev_b32 v3, 4, v1
  v_cmp_eq_u32 vcc, v2, v3
  s_mul_i32 s3, s31, 1280
  s_add_u32 s3, s3, 139264
  v_and_b32 v2, 15, v1
  v_lshlrev_b32 v2, 2, v2
  v_add_u32 v2, s3, v2
  s_nop 3
  v_cndmask_b32_e64 v28, v28, v29, s[48:49]
  v_cndmask_b32_e64 v28, v28, v30, s[50:51]
  v_cndmask_b32_e64 v28, v28, v31, s[52:53]
  v_cndmask_b32_e64 v40, v40, v41, s[48:49]
  v_cndmask_b32_e64 v40, v40, v42, s[50:51]
  v_cndmask_b32_e64 v40, v40, v43, s[52:53]
  v_cndmask_b32_e64 v32, v32, v33, s[48:49]
  v_cndmask_b32_e64 v32, v32, v34, s[50:51]
  v_cndmask_b32_e64 v32, v32, v35, s[52:53]
  v_cndmask_b32_e64 v44, v44, v45, s[48:49]
  v_cndmask_b32_e64 v44, v44, v46, s[50:51]
  v_cndmask_b32_e64 v44, v44, v47, s[52:53]
  v_cndmask_b32_e64 v36, v36, v37, s[48:49]
  v_cndmask_b32_e64 v36, v36, v38, s[50:51]
  v_cndmask_b32_e64 v36, v36, v39, s[52:53]
  v_cndmask_b32_e64 v48, v48, v49, s[48:49]
  v_cndmask_b32_e64 v48, v48, v50, s[50:51]
  v_cndmask_b32_e64 v48, v48, v51, s[52:53]
  s_and_saveexec_b64 s[38:39], vcc
  ds_write_b32 v2, v40 offset:0
  ds_write_b32 v2, v28 offset:320
  ds_write_b32 v2, v44 offset:64
  ds_write_b32 v2, v32 offset:384
  ds_write_b32 v2, v48 offset:128
  ds_write_b32 v2, v36 offset:448
  s_mov_b64 exec, s[38:39]
  s_waitcnt lgkmcnt(0)
  s_barrier
  s_branch sequential_preLN__sliding_local_dilated__glu_gated_geglu__prompt_kernel_fin
sequential_preLN__sliding_local_dilated__glu_gated_geglu__prompt_kernel_pref:
  s_barrier
  ds_read_b128 v[16:19], v10 offset:0
  ds_read_b128 v[20:23], v10 offset:2048
  ds_read_b128 v[24:27], v10 offset:4096
  s_waitcnt lgkmcnt(2)
  v_mfma_f32_16x16x32_bf16 v[28:31], v[16:19], v[16:19], 0
  v_mfma_f32_16x16x32_bf16 v[40:43], v[16:19], v[12:15], 0
  s_waitcnt lgkmcnt(1)
  v_mfma_f32_16x16x32_bf16 v[32:35], v[20:23], v[20:23], 0
  v_mfma_f32_16x16x32_bf16 v[44:47], v[20:23], v[12:15], 0
  s_waitcnt lgkmcnt(0)
  v_mfma_f32_16x16x32_bf16 v[36:39], v[24:27], v[24:27], 0
  v_mfma_f32_16x16x32_bf16 v[48:51], v[24:27], v[12:15], 0
  s_barrier
  ds_read_b128 v[16:19], v10 offset:34816
  ds_read_b128 v[20:23], v10 offset:36864
  ds_read_b128 v[24:27], v10 offset:38912
  s_waitcnt lgkmcnt(2)
  v_mfma_f32_16x16x32_bf16 v[28:31], v[16:19], v[16:19], v[28:31]
  v_mfma_f32_16x16x32_bf16 v[40:43], v[16:19], v[12:15], v[40:43]
  s_waitcnt lgkmcnt(1)
  v_mfma_f32_16x16x32_bf16 v[32:35], v[20:23], v[20:23], v[32:35]
  v_mfma_f32_16x16x32_bf16 v[44:47], v[20:23], v[12:15], v[44:47]
  s_waitcnt lgkmcnt(0)
  v_mfma_f32_16x16x32_bf16 v[36:39], v[24:27], v[24:27], v[36:39]
  v_mfma_f32_16x16x32_bf16 v[48:51], v[24:27], v[12:15], v[48:51]
  s_barrier
  ds_read_b128 v[16:19], v11 offset:0
  ds_read_b128 v[20:23], v11 offset:2048
  ds_read_b128 v[24:27], v11 offset:4096
  s_waitcnt lgkmcnt(2)
  v_mfma_f32_16x16x32_bf16 v[28:31], v[16:19], v[16:19], v[28:31]
  v_mfma_f32_16x16x32_bf16 v[40:43], v[16:19], v[12:15], v[40:43]
  s_waitcnt lgkmcnt(1)
  v_mfma_f32_16x16x32_bf16 v[32:35], v[20:23], v[20:23], v[32:35]
  v_mfma_f32_16x16x32_bf16 v[44:47], v[20:23], v[12:15], v[44:47]
  s_waitcnt lgkmcnt(0)
  v_mfma_f32_16x16x32_bf16 v[36:39], v[24:27], v[24:27], v[36:39]
  v_mfma_f32_16x16x32_bf16 v[48:51], v[24:27], v[12:15], v[48:51]
  s_barrier
  ds_read_b128 v[16:19], v11 offset:34816
  ds_read_b128 v[20:23], v11 offset:36864
  ds_read_b128 v[24:27], v11 offset:38912
  s_waitcnt lgkmcnt(2)
  v_mfma_f32_16x16x32_bf16 v[28:31], v[16:19], v[16:19], v[28:31]
  v_mfma_f32_16x16x32_bf16 v[40:43], v[16:19], v[12:15], v[40:43]
  s_waitcnt lgkmcnt(1)
  v_mfma_f32_16x16x32_bf16 v[32:35], v[20:23], v[20:23], v[32:35]
  v_mfma_f32_16x16x32_bf16 v[44:47], v[20:23], v[12:15], v[44:47]
  s_waitcnt lgkmcnt(0)
  v_mfma_f32_16x16x32_bf16 v[36:39], v[24:27], v[24:27], v[36:39]
  v_mfma_f32_16x16x32_bf16 v[48:51], v[24:27], v[12:15], v[48:51]
  s_barrier
  ds_read_b128 v[16:19], v10 offset:0
  ds_read_b128 v[20:23], v10 offset:2048
  ds_read_b128 v[24:27], v10 offset:4096
  s_waitcnt lgkmcnt(2)
  v_mfma_f32_16x16x32_bf16 v[28:31], v[16:19], v[16:19], v[28:31]
  v_mfma_f32_16x16x32_bf16 v[40:43], v[16:19], v[12:15], v[40:43]
  s_waitcnt lgkmcnt(1)
  v_mfma_f32_16x16x32_bf16 v[32:35], v[20:23], v[20:23], v[32:35]
  v_mfma_f32_16x16x32_bf16 v[44:47], v[20:23], v[12:15], v[44:47]
  s_waitcnt lgkmcnt(0)
  v_mfma_f32_16x16x32_bf16 v[36:39], v[24:27], v[24:27], v[36:39]
  v_mfma_f32_16x16x32_bf16 v[48:51], v[24:27], v[12:15], v[48:51]
  s_barrier
  ds_read_b128 v[16:19], v10 offset:34816
  ds_read_b128 v[20:23], v10 offset:36864
  ds_read_b128 v[24:27], v10 offset:38912
  s_waitcnt lgkmcnt(2)
  v_mfma_f32_16x16x32_bf16 v[28:31], v[16:19], v[16:19], v[28:31]
  v_mfma_f32_16x16x32_bf16 v[40:43], v[16:19], v[12:15], v[40:43]
  s_waitcnt lgkmcnt(1)
  v_mfma_f32_16x16x32_bf16 v[32:35], v[20:23], v[20:23], v[32:35]
  v_mfma_f32_16x16x32_bf16 v[44:47], v[20:23], v[12:15], v[44:47]
  s_waitcnt lgkmcnt(0)
  v_mfma_f32_16x16x32_bf16 v[36:39], v[24:27], v[24:27], v[36:39]
  v_mfma_f32_16x16x32_bf16 v[48:51], v[24:27], v[12:15], v[48:51]
  s_barrier
  s_mov_b32 s8, s6
  s_mov_b32 s9, s7
  s_mov_b32 s10, 0x80000
  s_mov_b32 s11, 0x00020000
  v_lshrrev_b32 v4, 2, v1
  v_lshlrev_b32 v4, 10, v4
  v_and_b32 v3, 3, v1
  v_lshl_add_u32 v4, v3, 7, v4
  s_lshr_b32 s34, s2, 3
  s_lshl_b32 s34, s34, 14
  s_and_b32 s35, s2, 1
  s_lshl_b32 s35, s35, 9
  s_add_u32 s34, s34, s35
  buffer_load_dword v56, v4, s[8:11], s34 offen
  v_lshlrev_b32 v2, 7, v1
  s_mul_i32 s3, s2, 7168
  v_cmp_gt_u32 vcc, 56, v1
  s_and_saveexec_b64 s[38:39], vcc
  s_mov_b32 s12, s20
  s_mov_b32 s13, s21
  s_mov_b32 s14, 0x1c0000
  s_mov_b32 s15, 0x00020000
  buffer_load_dword v57, v2, s[12:15], s3 offen
  s_mov_b32 s12, s22
  s_mov_b32 s13, s23
  s_mov_b32 s14, 0x1c0000
  s_mov_b32 s15, 0x00020000
  buffer_load_dword v57, v2, s[12:15], s3 offen
  s_mov_b64 exec, s[38:39]
  ds_read_b128 v[16:19], v11 offset:0
  ds_read_b128 v[20:23], v11 offset:2048
  ds_read_b128 v[24:27], v11 offset:4096
  s_waitcnt lgkmcnt(2)
  v_mfma_f32_16x16x32_bf16 v[28:31], v[16:19], v[16:19], v[28:31]
  v_mfma_f32_16x16x32_bf16 v[40:43], v[16:19], v[12:15], v[40:43]
  s_waitcnt lgkmcnt(1)
  v_mfma_f32_16x16x32_bf16 v[32:35], v[20:23], v[20:23], v[32:35]
  v_mfma_f32_16x16x32_bf16 v[44:47], v[20:23], v[12:15], v[44:47]
  s_waitcnt lgkmcnt(0)
  v_mfma_f32_16x16x32_bf16 v[36:39], v[24:27], v[24:27], v[36:39]
  v_mfma_f32_16x16x32_bf16 v[48:51], v[24:27], v[12:15], v[48:51]
  s_barrier
  s_waitcnt lgkmcnt(0)
  s_memrealtime s[56:57]
  s_waitcnt lgkmcnt(0)
  ds_read_b128 v[16:19], v11 offset:34816
  ds_read_b128 v[20:23], v11 offset:36864
  ds_read_b128 v[24:27], v11 offset:38912
  s_waitcnt lgkmcnt(2)
  v_mfma_f32_16x16x32_bf16 v[28:31], v[16:19], v[16:19], v[28:31]
  v_mfma_f32_16x16x32_bf16 v[40:43], v[16:19], v[12:15], v[40:43]
  s_waitcnt lgkmcnt(1)
  v_mfma_f32_16x16x32_bf16 v[32:35], v[20:23], v[20:23], v[32:35]
  v_mfma_f32_16x16x32_bf16 v[44:47], v[20:23], v[12:15], v[44:47]
  s_waitcnt lgkmcnt(0)
  v_mfma_f32_16x16x32_bf16 v[36:39], v[24:27], v[24:27], v[36:39]
  v_mfma_f32_16x16x32_bf16 v[48:51], v[24:27], v[12:15], v[48:51]
  v_and_b32 v2, 3, v1
  v_cmp_eq_u32 s[48:49], 1, v2
  v_cmp_eq_u32 s[50:51], 2, v2
  v_cmp_eq_u32 s[52:53], 3, v2
  v_bfe_u32 v2, v1, 2, 2
  v_lshrrev_b32 v3, 4, v1
  v_cmp_eq_u32 vcc, v2, v3
  s_mul_i32 s3, s31, 1280
  s_add_u32 s3, s3, 139264
  v_and_b32 v2, 15, v1
  v_lshlrev_b32 v2, 2, v2
  v_add_u32 v2, s3, v2
  s_nop 3
  v_cndmask_b32_e64 v28, v28, v29, s[48:49]
  v_cndmask_b32_e64 v28, v28, v30, s[50:51]
  v_cndmask_b32_e64 v28, v28, v31, s[52:53]
  v_cndmask_b32_e64 v40, v40, v41, s[48:49]
  v_cndmask_b32_e64 v40, v40, v42, s[50:51]
  v_cndmask_b32_e64 v40, v40, v43, s[52:53]
  v_cndmask_b32_e64 v32, v32, v33, s[48:49]
  v_cndmask_b32_e64 v32, v32, v34, s[50:51]
  v_cndmask_b32_e64 v32, v32, v35, s[52:53]
  v_cndmask_b32_e64 v44, v44, v45, s[48:49]
  v_cndmask_b32_e64 v44, v44, v46, s[50:51]
  v_cndmask_b32_e64 v44, v44, v47, s[52:53]
  v_cndmask_b32_e64 v36, v36, v37, s[48:49]
  v_cndmask_b32_e64 v36, v36, v38, s[50:51]
  v_cndmask_b32_e64 v36, v36, v39, s[52:53]
  v_cndmask_b32_e64 v48, v48, v49, s[48:49]
  v_cndmask_b32_e64 v48, v48, v50, s[50:51]
  v_cndmask_b32_e64 v48, v48, v51, s[52:53]
  s_and_saveexec_b64 s[38:39], vcc
  ds_write_b32 v2, v40 offset:0
  ds_write_b32 v2, v28 offset:320
  ds_write_b32 v2, v44 offset:64
  ds_write_b32 v2, v32 offset:384
  ds_write_b32 v2, v48 offset:128
  ds_write_b32 v2, v36 offset:448
  s_mov_b64 exec, s[38:39]
  s_waitcnt lgkmcnt(0)
  s_barrier
sequential_preLN__sliding_local_dilated__glu_gated_geglu__prompt_kernel_fin:
  s_mul_i32 s3, s31, 160
  s_add_u32 s3, s3, 139264
  v_lshlrev_b32 v2, 2, v1
  v_add_u32 v2, s3, v2
  v_cmp_gt_u32 vcc, 40, v1
  s_and_saveexec_b64 s[38:39], vcc
  ds_read_b32 v3, v2
  ds_read_b32 v9, v2 offset:320
  ds_read_b32 v4, v2 offset:1280
  ds_read_b32 v5, v2 offset:1600
  s_waitcnt lgkmcnt(0)
  v_add_f32 v3, v3, v4
  v_add_f32 v9, v9, v5
  v_mul_f32 v3, 0x3b000000, v3
  v_mul_f32 v9, 0x3b000000, v9
  v_fma_f32 v9, -v3, v3, v9
  v_max_f32 v9, 0, v9
  v_add_f32 v9, 0x3727c5ac, v9
  v_rsq_f32 v9, v9
  s_nop 0
  v_mul_f32 v3, v3, v9
  v_sub_f32 v3, 0, v3
  ds_write_b32 v2, v9 offset:640
  ds_write_b32 v2, v3 offset:960
  s_waitcnt lgkmcnt(0)
  s_mov_b64 exec, s[38:39]
  s_barrier
  s_barrier
  s_barrier
  s_cmp_eq_u32 s28, 4
  s_cbranch_scc1 sequential_preLN__sliding_local_dilated__glu_gated_geglu__prompt_kernel_nopoll
  s_add_u32 s8, s4, 0xd00000
  s_addc_u32 s9, s5, 0
  s_mov_b32 s10, 0x8000
  s_mov_b32 s11, 0x00020000
  s_lshl_b32 s3, s29, 3
  s_add_u32 s34, s3, s30
  s_lshl_b32 s34, s34, 7
  v_mov_b32 v2, s34
  s_lshl_b32 s3, s3, 7
  v_and_b32 v3, 7, v1
  v_lshlrev_b32 v3, 7, v3
  v_add_u32 v3, s3, v3
  s_waitcnt lgkmcnt(0)
  v_mov_b32 v4, s56
  v_mov_b32 v5, s57
  v_xor_b32 v6, 0x5bd1e995, v4
  v_xor_b32 v7, 0x9e3779b9, v5
  v_cmp_eq_u32 vcc, 0, v1
  s_and_saveexec_b64 s[38:39], vcc
  buffer_store_dwordx4 v[4:7], v2, s[8:11], 0 offen sc1
  s_mov_b64 exec, s[38:39]
  s_sub_u32 s54, s54, 200
  s_subb_u32 s55, s55, 0
  s_mov_b32 s35, 0
sequential_preLN__sliding_local_dilated__glu_gated_geglu__prompt_kernel_poll:
  buffer_load_dwordx4 v[8:11], v3, s[8:11], 0 offen sc1
  s_waitcnt vmcnt(0)
  v_xor_b32 v10, v10, v8
  v_xor_b32 v11, v11, v9
  v_subrev_co_u32 v8, vcc, s54, v8
  v_mov_b32 v12, s55
  s_nop 0
  v_subb_co_u32 v9, vcc, v9, v12, vcc
  v_xor_b32 v10, 0x5bd1e995, v10
  v_xor_b32 v11, 0x9e3779b9, v11
  v_lshrrev_b32 v8, 20, v8
  v_or_b32 v8, v8, v9
  v_or3_b32 v8, v8, v10, v11
  v_cmp_eq_u32 vcc, 0, v8
  s_add_u32 s35, s35, 1
  s_cmp_eq_u64 vcc, exec
  s_cbranch_scc1 sequential_preLN__sliding_local_dilated__glu_gated_geglu__prompt_kernel_nopoll
  s_cmp_lt_u32 s35, 0x10000
  s_cbranch_scc1 sequential_preLN__sliding_local_dilated__glu_gated_geglu__prompt_kernel_poll
sequential_preLN__sliding_local_dilated__glu_gated_geglu__prompt_kernel_nopoll:
  s_barrier
  s_barrier
  s_barrier
  s_cmp_eq_u32 s28, 4
  s_cbranch_scc1 k3_kernel
  s_add_u32 s8, s4, 0xd08000
  s_addc_u32 s9, s5, 0
  s_mov_b32 s10, 0x8000
  s_mov_b32 s11, 0x00020000
  v_mov_b32 v4, s56
  v_mov_b32 v5, s57
  v_xor_b32 v6, 0x5bd1e995, v4
  v_xor_b32 v7, 0x9e3779b9, v5
  v_cmp_eq_u32 vcc, 0, v1
  s_and_saveexec_b64 s[38:39], vcc
  buffer_store_dwordx4 v[4:7], v2, s[8:11], 0 offen sc1
  s_mov_b64 exec, s[38:39]
  s_branch k3_kernel
  s_waitcnt vmcnt(0)
  s_endpgm
sequential_preLN__sliding_local_dilated__glu_gated_geglu__prompt_kernel_end:
  s_endpgm
sequential_preLN__sliding_local_dilated__glu_gated_geglu__prompt_kernel_compute:
  s_mov_b32 s16, s4
  s_mov_b32 s17, s5
  s_mov_b32 s18, 0x200000
  s_mov_b32 s19, 0x00020000
  v_and_b32 v12, 15, v1
  v_lshrrev_b32 v13, 4, v1
  v_lshrrev_b32 v14, 1, v12
  v_xor_b32 v14, v14, v13
  v_lshlrev_b32 v15, 7, v12
  v_lshl_add_u32 v2, v14, 4, v15
  v_xor_b32 v14, 4, v14
  v_lshl_add_u32 v3, v14, 4, v15
  v_add_u32 v4, 69632, v2
  v_add_u32 v5, 69632, v3
  v_bfe_u32 v14, v1, 2, 2
  v_lshl_add_u32 v14, v13, 3, v14
  v_lshlrev_b32 v14, 7, v14
  v_and_b32 v15, 3, v1
  v_lshl_add_u32 v14, v15, 3, v14
  v_bfe_u32 v15, v1, 3, 1
  v_bfe_u32 v12, v1, 4, 1
  v_lshl_or_b32 v12, v12, 1, v15
  v_xor_b32 v12, s28, v12
  v_lshl_add_u32 v6, v12, 5, v14
  v_add_u32 v6, 10240, v6
  v_add_u32 v7, 69632, v6
  v_mov_b32 v8, 0x3f803f80
  v_mov_b32 v9, 0x3f803f80
  v_mov_b32 v10, 0x3f803f80
  v_mov_b32 v11, 0x3f803f80
  v_add_u32 v4, 34816, v2
  v_add_u32 v7, 34816, v6
  s_mov_b32 s42, 1
  s_mov_b32 s43, 0
  v_mov_b32 v80, 0
  v_mov_b32 v81, 0
  v_mov_b32 v82, 0
  v_mov_b32 v83, 0
  v_mov_b32 v84, 0
  v_mov_b32 v85, 0
  v_mov_b32 v86, 0
  v_mov_b32 v87, 0
  v_mov_b32 v88, 0
  v_mov_b32 v89, 0
  v_mov_b32 v90, 0
  v_mov_b32 v91, 0
  v_mov_b32 v92, 0
  v_mov_b32 v93, 0
  v_mov_b32 v94, 0
  v_mov_b32 v95, 0
  v_mov_b32 v96, 0
  v_mov_b32 v97, 0
  v_mov_b32 v98, 0
  v_mov_b32 v99, 0
  v_mov_b32 v100, 0
  v_mov_b32 v101, 0
  v_mov_b32 v102, 0
  v_mov_b32 v103, 0
  v_mov_b32 v104, 0
  v_mov_b32 v105, 0
  v_mov_b32 v106, 0
  v_mov_b32 v107, 0
  v_mov_b32 v108, 0
  v_mov_b32 v109, 0
  v_mov_b32 v110, 0
  v_mov_b32 v111, 0
  v_mov_b32 v112, 0
  v_mov_b32 v113, 0
  v_mov_b32 v114, 0
  v_mov_b32 v115, 0
  v_mov_b32 v116, 0
  v_mov_b32 v117, 0
  v_mov_b32 v118, 0
  v_mov_b32 v119, 0
  v_mov_b32 v120, 0
  v_mov_b32 v121, 0
  v_mov_b32 v122, 0
  v_mov_b32 v123, 0
  v_mov_b32 v124, 0
  v_mov_b32 v125, 0
  v_mov_b32 v126, 0
  v_mov_b32 v127, 0
  v_mov_b32 v128, 0
  v_mov_b32 v129, 0
  v_mov_b32 v130, 0
  v_mov_b32 v131, 0
  v_mov_b32 v132, 0
  v_mov_b32 v133, 0
  v_mov_b32 v134, 0
  v_mov_b32 v135, 0
  v_mov_b32 v136, 0
  v_mov_b32 v137, 0
  v_mov_b32 v138, 0
  v_mov_b32 v139, 0
  v_mov_b32 v140, 0
  v_mov_b32 v141, 0
  v_mov_b32 v142, 0
  v_mov_b32 v143, 0
  v_mov_b32 v144, 0
  v_mov_b32 v145, 0
  v_mov_b32 v146, 0
  v_mov_b32 v147, 0
  s_barrier
  ds_read_b64_tr_b16 v[60:61], v6 offset:8192
  ds_read_b64_tr_b16 v[62:63], v6 offset:8704
  ds_read_b128 v[16:19], v2 offset:0
  ds_read_b64_tr_b16 v[64:65], v6 offset:16384
  ds_read_b64_tr_b16 v[66:67], v6 offset:16896
  ds_read_b128 v[20:23], v2 offset:2048
  ds_read_b64_tr_b16 v[56:57], v6 offset:0
  ds_read_b64_tr_b16 v[58:59], v6 offset:512
  ds_read_b128 v[24:27], v2 offset:4096
  ds_read_b128 v[28:31], v2 offset:6144
  ds_read_b128 v[32:35], v2 offset:8192
sequential_preLN__sliding_local_dilated__glu_gated_geglu__prompt_kernel_loop:
  s_waitcnt lgkmcnt(9)
  s_waitcnt lgkmcnt(8)
  v_mfma_f32_16x16x32_bf16 v[96:99], v[60:63], v[16:19], v[96:99]
  ds_read_b64_tr_b16 v[72:73], v6 offset:12288
  ds_read_b64_tr_b16 v[74:75], v6 offset:12800
  s_waitcnt lgkmcnt(8)
  v_mfma_f32_16x16x32_bf16 v[116:119], v[16:19], v[64:67], v[116:119]
  s_waitcnt lgkmcnt(7)
  v_mfma_f32_16x16x32_bf16 v[100:103], v[60:63], v[20:23], v[100:103]
  ds_read_b128 v[36:39], v3 offset:0
  v_mfma_f32_16x16x32_bf16 v[120:123], v[20:23], v[64:67], v[120:123]
  s_waitcnt lgkmcnt(6)
  v_mfma_f32_16x16x32_bf16 v[80:83], v[56:59], v[20:23], v[80:83]
  ds_read_b64_tr_b16 v[76:77], v6 offset:20480
  ds_read_b64_tr_b16 v[78:79], v6 offset:20992
  s_waitcnt lgkmcnt(7)
  v_mfma_f32_16x16x32_bf16 v[104:107], v[60:63], v[24:27], v[104:107]
  v_mfma_f32_16x16x32_bf16 v[124:127], v[24:27], v[64:67], v[124:127]
  ds_read_b128 v[40:43], v3 offset:2048
  v_mfma_f32_16x16x32_bf16 v[84:87], v[56:59], v[24:27], v[84:87]
  s_waitcnt lgkmcnt(7)
  v_mfma_f32_16x16x32_bf16 v[108:111], v[60:63], v[28:31], v[108:111]
  ds_read_b64_tr_b16 v[68:69], v6 offset:4096
  ds_read_b64_tr_b16 v[70:71], v6 offset:4608
  v_mfma_f32_16x16x32_bf16 v[128:131], v[28:31], v[64:67], v[128:131]
  ds_read_b128 v[44:47], v3 offset:4096
  v_mfma_f32_16x16x32_bf16 v[88:91], v[56:59], v[28:31], v[88:91]
  ds_read_b128 v[48:51], v3 offset:6144
  s_waitcnt lgkmcnt(10)
  v_mfma_f32_16x16x32_bf16 v[112:115], v[60:63], v[32:35], v[112:115]
  ds_read_b128 v[52:55], v3 offset:8192
  v_mfma_f32_16x16x32_bf16 v[132:135], v[32:35], v[64:67], v[132:135]
  v_mfma_f32_16x16x32_bf16 v[92:95], v[56:59], v[32:35], v[92:95]
  v_mfma_f32_16x16x32_bf16 v[136:139], v[56:59], v[8:11], v[136:139]
  v_mfma_f32_16x16x32_bf16 v[140:143], v[60:63], v[8:11], v[140:143]
  v_mfma_f32_16x16x32_bf16 v[144:147], v[8:11], v[64:67], v[144:147]
  s_waitcnt lgkmcnt(9)
  s_waitcnt lgkmcnt(8)
  v_mfma_f32_16x16x32_bf16 v[96:99], v[72:75], v[36:39], v[96:99]
  s_waitcnt lgkmcnt(6)
  v_mfma_f32_16x16x32_bf16 v[116:119], v[36:39], v[76:79], v[116:119]
  s_waitcnt lgkmcnt(5)
  v_mfma_f32_16x16x32_bf16 v[100:103], v[72:75], v[40:43], v[100:103]
  v_mfma_f32_16x16x32_bf16 v[120:123], v[40:43], v[76:79], v[120:123]
  s_waitcnt lgkmcnt(3)
  v_mfma_f32_16x16x32_bf16 v[80:83], v[68:71], v[40:43], v[80:83]
  s_waitcnt lgkmcnt(2)
  v_mfma_f32_16x16x32_bf16 v[104:107], v[72:75], v[44:47], v[104:107]
  s_waitcnt lgkmcnt(0)
  s_barrier
  ds_read_b64_tr_b16 v[60:61], v7 offset:8192
  ds_read_b64_tr_b16 v[62:63], v7 offset:8704
  v_mfma_f32_16x16x32_bf16 v[124:127], v[44:47], v[76:79], v[124:127]
  ds_read_b128 v[16:19], v4 offset:0
  v_mfma_f32_16x16x32_bf16 v[84:87], v[68:71], v[44:47], v[84:87]
  ds_read_b64_tr_b16 v[64:65], v7 offset:16384
  ds_read_b64_tr_b16 v[66:67], v7 offset:16896
  v_mfma_f32_16x16x32_bf16 v[108:111], v[72:75], v[48:51], v[108:111]
  ds_read_b128 v[20:23], v4 offset:2048
  v_mfma_f32_16x16x32_bf16 v[128:131], v[48:51], v[76:79], v[128:131]
  ds_read_b64_tr_b16 v[56:57], v7 offset:0
  ds_read_b64_tr_b16 v[58:59], v7 offset:512
  v_mfma_f32_16x16x32_bf16 v[88:91], v[68:71], v[48:51], v[88:91]
  ds_read_b128 v[24:27], v4 offset:4096
  v_mfma_f32_16x16x32_bf16 v[112:115], v[72:75], v[52:55], v[112:115]
  ds_read_b128 v[28:31], v4 offset:6144
  v_mfma_f32_16x16x32_bf16 v[132:135], v[52:55], v[76:79], v[132:135]
  ds_read_b128 v[32:35], v4 offset:8192
  v_mfma_f32_16x16x32_bf16 v[92:95], v[68:71], v[52:55], v[92:95]
  v_mfma_f32_16x16x32_bf16 v[136:139], v[68:71], v[8:11], v[136:139]
  v_mfma_f32_16x16x32_bf16 v[140:143], v[72:75], v[8:11], v[140:143]
  v_mfma_f32_16x16x32_bf16 v[144:147], v[8:11], v[76:79], v[144:147]
  v_mov_b32 v2, v4
  v_xor_b32 v3, 64, v4
  v_mov_b32 v6, v7
  s_add_u32 s42, s42, 1
  s_cmp_eq_u32 s42, 4
  s_cselect_b32 s42, 0, s42
  s_mov_b32 s3, 34816
  s_cmov_b32 s3, 0xfffe6800
  v_add_u32 v4, s3, v4
  v_add_u32 v7, s3, v7
  s_add_u32 s43, s43, 1
  s_cmp_lt_u32 s43, 8
  s_cbranch_scc1 sequential_preLN__sliding_local_dilated__glu_gated_geglu__prompt_kernel_loop
  s_waitcnt lgkmcnt(0)
  s_barrier
  v_and_b32 v12, 15, v1
  v_lshlrev_b32 v14, 2, v12
  v_lshrrev_b32 v13, 4, v1
  v_lshlrev_b32 v15, 4, v13
  v_add_u32 v14, 139264, v14
  v_add_u32 v15, 139264, v15
  ds_read_b32 v148, v14 offset:640
  ds_read_b32 v153, v14 offset:960
  ds_read_b128 v[160:163], v15 offset:640
  ds_read_b128 v[180:183], v15 offset:960
  ds_read_b32 v149, v14 offset:704
  ds_read_b32 v154, v14 offset:1024
  ds_read_b128 v[164:167], v15 offset:704
  ds_read_b128 v[184:187], v15 offset:1024
  ds_read_b32 v150, v14 offset:768
  ds_read_b32 v155, v14 offset:1088
  ds_read_b128 v[168:171], v15 offset:768
  ds_read_b128 v[188:191], v15 offset:1088
  ds_read_b32 v151, v14 offset:832
  ds_read_b32 v156, v14 offset:1152
  ds_read_b128 v[172:175], v15 offset:832
  ds_read_b128 v[192:195], v15 offset:1152
  ds_read_b32 v152, v14 offset:896
  ds_read_b32 v157, v14 offset:1216
  ds_read_b128 v[176:179], v15 offset:896
  ds_read_b128 v[196:199], v15 offset:1216
  v_mov_b32 v212, 0xf149f2ca
  v_lshlrev_b32 v14, 2, v13
  v_sub_u32 v14, v12, v14
  v_mov_b32 v213, 0x80000000
  v_subrev_u32 v15, 0, v14
  v_and_b32 v15, 0x80000001, v15
  v_cmp_eq_u32 vcc, 0, v15
  v_cmp_eq_u32 s[38:39], v213, v15
  s_nop 1
  v_cndmask_b32_e64 v200, v212, 0, vcc
  v_cndmask_b32_e64 v204, v212, 0, s[38:39]
  v_subrev_u32 v15, 1, v14
  v_and_b32 v15, 0x80000001, v15
  v_cmp_eq_u32 vcc, 0, v15
  v_cmp_eq_u32 s[38:39], v213, v15
  s_nop 1
  v_cndmask_b32_e64 v201, v212, 0, vcc
  v_cndmask_b32_e64 v205, v212, 0, s[38:39]
  v_subrev_u32 v15, 2, v14
  v_and_b32 v15, 0x80000001, v15
  v_cmp_eq_u32 vcc, 0, v15
  v_cmp_eq_u32 s[38:39], v213, v15
  s_nop 1
  v_cndmask_b32_e64 v202, v212, 0, vcc
  v_cndmask_b32_e64 v206, v212, 0, s[38:39]
  v_subrev_u32 v15, 3, v14
  v_and_b32 v15, 0x80000001, v15
  v_cmp_eq_u32 vcc, 0, v15
  v_cmp_eq_u32 s[38:39], v213, v15
  s_nop 1
  v_cndmask_b32_e64 v203, v212, 0, vcc
  v_cndmask_b32_e64 v207, v212, 0, s[38:39]
  s_cmp_eq_u32 s29, 0
  s_cselect_b64 s[38:39], -1, 0
  v_cndmask_b32_e64 v208, v204, v212, s[38:39]
  v_cndmask_b32_e64 v209, v205, v212, s[38:39]
  v_cndmask_b32_e64 v210, v206, v212, s[38:39]
  v_cndmask_b32_e64 v211, v207, v212, s[38:39]
  s_mov_b32 s36, 0x3eb8aa3b
  s_waitcnt lgkmcnt(0)
  v_mul_f32 v12, v153, v140
  v_mul_f32 v13, v153, v141
  v_mul_f32 v14, v153, v142
  v_mul_f32 v15, v153, v143
  v_fma_f32 v12, v148, v96, v12
  v_fma_f32 v13, v148, v97, v13
  v_fma_f32 v14, v148, v98, v14
  v_fma_f32 v15, v148, v99, v15
  v_cvt_pk_bf16_f32 v24, v12, v13
  v_cvt_pk_bf16_f32 v25, v14, v15
  v_mul_f32 v12, v180, v144
  v_mul_f32 v13, v181, v144
  v_mul_f32 v14, v182, v144
  v_mul_f32 v15, v183, v144
  v_fma_f32 v12, v160, v116, v12
  v_fma_f32 v13, v161, v117, v13
  v_fma_f32 v14, v162, v118, v14
  v_fma_f32 v15, v163, v119, v15
  v_cvt_pk_bf16_f32 v34, v12, v13
  v_cvt_pk_bf16_f32 v35, v14, v15
  v_mul_f32 v12, v154, v136
  v_mul_f32 v13, v154, v137
  v_mul_f32 v14, v154, v138
  v_mul_f32 v15, v154, v139
  v_fma_f32 v12, v149, v80, v12
  v_fma_f32 v13, v149, v81, v13
  v_fma_f32 v14, v149, v82, v14
  v_fma_f32 v15, v149, v83, v15
  v_cvt_pk_bf16_f32 v16, v12, v13
  v_cvt_pk_bf16_f32 v17, v14, v15
  v_mul_f32 v12, v154, v140
  v_mul_f32 v13, v154, v141
  v_mul_f32 v14, v154, v142
  v_mul_f32 v15, v154, v143
  v_fma_f32 v12, v149, v100, v12
  v_fma_f32 v13, v149, v101, v13
  v_fma_f32 v14, v149, v102, v14
  v_fma_f32 v15, v149, v103, v15
  v_cvt_pk_bf16_f32 v26, v12, v13
  v_cvt_pk_bf16_f32 v27, v14, v15
  v_mul_f32 v12, v184, v144
  v_mul_f32 v13, v185, v144
  v_mul_f32 v14, v186, v144
  v_mul_f32 v15, v187, v144
  v_fma_f32 v12, v164, v120, v12
  v_fma_f32 v13, v165, v121, v13
  v_fma_f32 v14, v166, v122, v14
  v_fma_f32 v15, v167, v123, v15
  v_cvt_pk_bf16_f32 v36, v12, v13
  v_cvt_pk_bf16_f32 v37, v14, v15
  v_mul_f32 v12, v155, v136
  v_mul_f32 v13, v155, v137
  v_mul_f32 v14, v155, v138
  v_mul_f32 v15, v155, v139
  v_fma_f32 v12, v150, v84, v12
  v_fma_f32 v13, v150, v85, v13
  v_fma_f32 v14, v150, v86, v14
  v_fma_f32 v15, v150, v87, v15
  v_cvt_pk_bf16_f32 v18, v12, v13
  v_cvt_pk_bf16_f32 v19, v14, v15
  v_mul_f32 v12, v155, v140
  v_mul_f32 v13, v155, v141
  v_mul_f32 v14, v155, v142
  v_mul_f32 v15, v155, v143
  v_fma_f32 v12, v150, v104, v12
  v_fma_f32 v13, v150, v105, v13
  v_fma_f32 v14, v150, v106, v14
  v_fma_f32 v15, v150, v107, v15
  v_cvt_pk_bf16_f32 v28, v12, v13
  v_cvt_pk_bf16_f32 v29, v14, v15
  v_mul_f32 v12, v188, v144
  v_mul_f32 v13, v189, v144
  v_mul_f32 v14, v190, v144
  v_mul_f32 v15, v191, v144
  v_fma_f32 v12, v168, v124, v12
  v_fma_f32 v13, v169, v125, v13
  v_fma_f32 v14, v170, v126, v14
  v_fma_f32 v15, v171, v127, v15
  v_cvt_pk_bf16_f32 v38, v12, v13
  v_cvt_pk_bf16_f32 v39, v14, v15
  v_mul_f32 v12, v156, v136
  v_mul_f32 v13, v156, v137
  v_mul_f32 v14, v156, v138
  v_mul_f32 v15, v156, v139
  v_fma_f32 v12, v151, v88, v12
  v_fma_f32 v13, v151, v89, v13
  v_fma_f32 v14, v151, v90, v14
  v_fma_f32 v15, v151, v91, v15
  v_cvt_pk_bf16_f32 v20, v12, v13
  v_cvt_pk_bf16_f32 v21, v14, v15
  v_mul_f32 v12, v156, v140
  v_mul_f32 v13, v156, v141
  v_mul_f32 v14, v156, v142
  v_mul_f32 v15, v156, v143
  v_fma_f32 v12, v151, v108, v12
  v_fma_f32 v13, v151, v109, v13
  v_fma_f32 v14, v151, v110, v14
  v_fma_f32 v15, v151, v111, v15
  v_cvt_pk_bf16_f32 v30, v12, v13
  v_cvt_pk_bf16_f32 v31, v14, v15
  v_mul_f32 v12, v192, v144
  v_mul_f32 v13, v193, v144
  v_mul_f32 v14, v194, v144
  v_mul_f32 v15, v195, v144
  v_fma_f32 v12, v172, v128, v12
  v_fma_f32 v13, v173, v129, v13
  v_fma_f32 v14, v174, v130, v14
  v_fma_f32 v15, v175, v131, v15
  v_cvt_pk_bf16_f32 v40, v12, v13
  v_cvt_pk_bf16_f32 v41, v14, v15
  v_mul_f32 v12, v157, v136
  v_mul_f32 v13, v157, v137
  v_mul_f32 v14, v157, v138
  v_mul_f32 v15, v157, v139
  v_fma_f32 v12, v152, v92, v12
  v_fma_f32 v13, v152, v93, v13
  v_fma_f32 v14, v152, v94, v14
  v_fma_f32 v15, v152, v95, v15
  v_cvt_pk_bf16_f32 v22, v12, v13
  v_cvt_pk_bf16_f32 v23, v14, v15
  v_mul_f32 v12, v157, v140
  v_mul_f32 v13, v157, v141
  v_mul_f32 v14, v157, v142
  v_mul_f32 v15, v157, v143
  v_fma_f32 v12, v152, v112, v12
  v_fma_f32 v13, v152, v113, v13
  v_fma_f32 v14, v152, v114, v14
  v_fma_f32 v15, v152, v115, v15
  v_cvt_pk_bf16_f32 v32, v12, v13
  v_cvt_pk_bf16_f32 v33, v14, v15
  v_mul_f32 v12, v196, v144
  v_mul_f32 v13, v197, v144
  v_mul_f32 v14, v198, v144
  v_mul_f32 v15, v199, v144
  v_fma_f32 v12, v176, v132, v12
  v_fma_f32 v13, v177, v133, v13
  v_fma_f32 v14, v178, v134, v14
  v_fma_f32 v15, v179, v135, v15
  v_cvt_pk_bf16_f32 v42, v12, v13
  v_cvt_pk_bf16_f32 v43, v14, v15
  s_nop 1
  v_mfma_f32_16x16x16_bf16 v[80:83], v[24:25], v[16:17], 0
  v_mfma_f32_16x16x16_bf16 v[84:87], v[26:27], v[16:17], 0
  v_mfma_f32_16x16x16_bf16 v[88:91], v[26:27], v[18:19], 0
  v_mfma_f32_16x16x16_bf16 v[92:95], v[28:29], v[18:19], 0
  v_mfma_f32_16x16x16_bf16 v[96:99], v[28:29], v[20:21], 0
  v_mfma_f32_16x16x16_bf16 v[100:103], v[30:31], v[20:21], 0
  v_mfma_f32_16x16x16_bf16 v[104:107], v[30:31], v[22:23], 0
  v_mfma_f32_16x16x16_bf16 v[108:111], v[32:33], v[22:23], 0
  s_nop 7
  s_nop 1
  v_fma_f32 v80, v80, s36, v208
  v_fma_f32 v84, v84, s36, v200
  v_fma_f32 v81, v81, s36, v209
  v_fma_f32 v85, v85, s36, v201
  v_fma_f32 v82, v82, s36, v210
  v_fma_f32 v86, v86, s36, v202
  v_fma_f32 v83, v83, s36, v211
  v_fma_f32 v87, v87, s36, v203
  v_max3_f32 v148, v80, v81, v82
  v_max3_f32 v148, v148, v83, v84
  v_max3_f32 v148, v148, v85, v86
  v_max_f32 v148, v148, v87
  v_fma_f32 v88, v88, s36, v204
  v_fma_f32 v92, v92, s36, v200
  v_fma_f32 v89, v89, s36, v205
  v_fma_f32 v93, v93, s36, v201
  v_fma_f32 v90, v90, s36, v206
  v_fma_f32 v94, v94, s36, v202
  v_fma_f32 v91, v91, s36, v207
  v_fma_f32 v95, v95, s36, v203
  v_max3_f32 v149, v88, v89, v90
  v_max3_f32 v149, v149, v91, v92
  v_max3_f32 v149, v149, v93, v94
  v_max_f32 v149, v149, v95
  v_fma_f32 v96, v96, s36, v204
  v_fma_f32 v100, v100, s36, v200
  v_fma_f32 v97, v97, s36, v205
  v_fma_f32 v101, v101, s36, v201
  v_fma_f32 v98, v98, s36, v206
  v_fma_f32 v102, v102, s36, v202
  v_fma_f32 v99, v99, s36, v207
  v_fma_f32 v103, v103, s36, v203
  v_max3_f32 v150, v96, v97, v98
  v_max3_f32 v150, v150, v99, v100
  v_max3_f32 v150, v150, v101, v102
  v_max_f32 v150, v150, v103
  v_fma_f32 v104, v104, s36, v204
  v_fma_f32 v108, v108, s36, v200
  v_fma_f32 v105, v105, s36, v205
  v_fma_f32 v109, v109, s36, v201
  v_fma_f32 v106, v106, s36, v206
  v_fma_f32 v110, v110, s36, v202
  v_fma_f32 v107, v107, s36, v207
  v_fma_f32 v111, v111, s36, v203
  v_max3_f32 v151, v104, v105, v106
  v_max3_f32 v151, v151, v107, v108
  v_max3_f32 v151, v151, v109, v110
  v_max_f32 v151, v151, v111
  v_mov_b32 v152, v148
  v_mov_b32 v153, v149
  v_mov_b32 v154, v150
  v_mov_b32 v155, v151
  s_nop 1
  v_permlane32_swap_b32 v148, v152
  v_permlane32_swap_b32 v149, v153
  v_permlane32_swap_b32 v150, v154
  v_permlane32_swap_b32 v151, v155
  v_max_f32 v148, v148, v152
  v_max_f32 v149, v149, v153
  v_max_f32 v150, v150, v154
  v_max_f32 v151, v151, v155
  v_mov_b32 v152, v148
  v_mov_b32 v153, v149
  v_mov_b32 v154, v150
  v_mov_b32 v155, v151
  s_nop 1
  v_permlane16_swap_b32 v148, v152
  v_permlane16_swap_b32 v149, v153
  v_permlane16_swap_b32 v150, v154
  v_permlane16_swap_b32 v151, v155
  v_max_f32 v148, v148, v152
  v_max_f32 v149, v149, v153
  v_max_f32 v150, v150, v154
  v_max_f32 v151, v151, v155
  v_sub_f32 v80, v80, v148
  v_sub_f32 v81, v81, v148
  v_sub_f32 v82, v82, v148
  v_sub_f32 v83, v83, v148
  v_sub_f32 v84, v84, v148
  v_sub_f32 v85, v85, v148
  v_sub_f32 v86, v86, v148
  v_sub_f32 v87, v87, v148
  v_exp_f32 v80, v80
  v_exp_f32 v81, v81
  v_exp_f32 v82, v82
  v_exp_f32 v83, v83
  v_exp_f32 v84, v84
  v_exp_f32 v85, v85
  v_exp_f32 v86, v86
  v_exp_f32 v87, v87
  s_nop 0
  v_add_f32 v156, v80, v81
  v_add_f32 v156, v156, v82
  v_add_f32 v156, v156, v83
  v_add_f32 v156, v156, v84
  v_add_f32 v156, v156, v85
  v_add_f32 v156, v156, v86
  v_add_f32 v156, v156, v87
  v_sub_f32 v88, v88, v149
  v_sub_f32 v89, v89, v149
  v_sub_f32 v90, v90, v149
  v_sub_f32 v91, v91, v149
  v_sub_f32 v92, v92, v149
  v_sub_f32 v93, v93, v149
  v_sub_f32 v94, v94, v149
  v_sub_f32 v95, v95, v149
  v_exp_f32 v88, v88
  v_exp_f32 v89, v89
  v_exp_f32 v90, v90
  v_exp_f32 v91, v91
  v_exp_f32 v92, v92
  v_exp_f32 v93, v93
  v_exp_f32 v94, v94
  v_exp_f32 v95, v95
  s_nop 0
  v_add_f32 v157, v88, v89
  v_add_f32 v157, v157, v90
  v_add_f32 v157, v157, v91
  v_add_f32 v157, v157, v92
  v_add_f32 v157, v157, v93
  v_add_f32 v157, v157, v94
  v_add_f32 v157, v157, v95
  v_sub_f32 v96, v96, v150
  v_sub_f32 v97, v97, v150
  v_sub_f32 v98, v98, v150
  v_sub_f32 v99, v99, v150
  v_sub_f32 v100, v100, v150
  v_sub_f32 v101, v101, v150
  v_sub_f32 v102, v102, v150
  v_sub_f32 v103, v103, v150
  v_exp_f32 v96, v96
  v_exp_f32 v97, v97
  v_exp_f32 v98, v98
  v_exp_f32 v99, v99
  v_exp_f32 v100, v100
  v_exp_f32 v101, v101
  v_exp_f32 v102, v102
  v_exp_f32 v103, v103
  s_nop 0
  v_add_f32 v158, v96, v97
  v_add_f32 v158, v158, v98
  v_add_f32 v158, v158, v99
  v_add_f32 v158, v158, v100
  v_add_f32 v158, v158, v101
  v_add_f32 v158, v158, v102
  v_add_f32 v158, v158, v103
  v_sub_f32 v104, v104, v151
  v_sub_f32 v105, v105, v151
  v_sub_f32 v106, v106, v151
  v_sub_f32 v107, v107, v151
  v_sub_f32 v108, v108, v151
  v_sub_f32 v109, v109, v151
  v_sub_f32 v110, v110, v151
  v_sub_f32 v111, v111, v151
  v_exp_f32 v104, v104
  v_exp_f32 v105, v105
  v_exp_f32 v106, v106
  v_exp_f32 v107, v107
  v_exp_f32 v108, v108
  v_exp_f32 v109, v109
  v_exp_f32 v110, v110
  v_exp_f32 v111, v111
  s_nop 0
  v_add_f32 v159, v104, v105
  v_add_f32 v159, v159, v106
  v_add_f32 v159, v159, v107
  v_add_f32 v159, v159, v108
  v_add_f32 v159, v159, v109
  v_add_f32 v159, v159, v110
  v_add_f32 v159, v159, v111
  v_cvt_pk_bf16_f32 v160, v80, v81
  v_cvt_pk_bf16_f32 v161, v82, v83
  v_cvt_pk_bf16_f32 v162, v84, v85
  v_cvt_pk_bf16_f32 v163, v86, v87
  v_cvt_pk_bf16_f32 v164, v88, v89
  v_cvt_pk_bf16_f32 v165, v90, v91
  v_cvt_pk_bf16_f32 v166, v92, v93
  v_cvt_pk_bf16_f32 v167, v94, v95
  v_cvt_pk_bf16_f32 v168, v96, v97
  v_cvt_pk_bf16_f32 v169, v98, v99
  v_cvt_pk_bf16_f32 v170, v100, v101
  v_cvt_pk_bf16_f32 v171, v102, v103
  v_cvt_pk_bf16_f32 v172, v104, v105
  v_cvt_pk_bf16_f32 v173, v106, v107
  v_cvt_pk_bf16_f32 v174, v108, v109
  v_cvt_pk_bf16_f32 v175, v110, v111
  v_mov_b32 v152, v156
  v_mov_b32 v153, v157
  v_mov_b32 v154, v158
  v_mov_b32 v155, v159
  s_nop 1
  v_permlane32_swap_b32 v156, v152
  v_permlane32_swap_b32 v157, v153
  v_permlane32_swap_b32 v158, v154
  v_permlane32_swap_b32 v159, v155
  v_add_f32 v156, v156, v152
  v_add_f32 v157, v157, v153
  v_add_f32 v158, v158, v154
  v_add_f32 v159, v159, v155
  v_mov_b32 v152, v156
  v_mov_b32 v153, v157
  v_mov_b32 v154, v158
  v_mov_b32 v155, v159
  s_nop 1
  v_permlane16_swap_b32 v156, v152
  v_permlane16_swap_b32 v157, v153
  v_permlane16_swap_b32 v158, v154
  v_permlane16_swap_b32 v159, v155
  v_add_f32 v156, v156, v152
  v_add_f32 v157, v157, v153
  v_add_f32 v158, v158, v154
  v_add_f32 v159, v159, v155
  v_mfma_f32_16x16x16_bf16 v[176:179], v[34:35], v[160:161], 0
  v_mfma_f32_16x16x16_bf16 v[180:183], v[36:37], v[164:165], 0
  v_mfma_f32_16x16x16_bf16 v[184:187], v[38:39], v[168:169], 0
  v_mfma_f32_16x16x16_bf16 v[188:191], v[40:41], v[172:173], 0
  v_mfma_f32_16x16x16_bf16 v[176:179], v[36:37], v[162:163], v[176:179]
  v_mfma_f32_16x16x16_bf16 v[180:183], v[38:39], v[166:167], v[180:183]
  v_mfma_f32_16x16x16_bf16 v[184:187], v[40:41], v[170:171], v[184:187]
  v_mfma_f32_16x16x16_bf16 v[188:191], v[42:43], v[174:175], v[188:191]
  v_rcp_f32 v156, v156
  v_rcp_f32 v157, v157
  v_rcp_f32 v158, v158
  v_rcp_f32 v159, v159
  v_and_b32 v12, 15, v1
  v_mul_u32_u24 v12, 144, v12
  v_lshrrev_b32 v13, 4, v1
  v_lshl_add_u32 v12, v13, 3, v12
  s_lshl_b32 s3, s28, 5
  v_add_u32 v12, s3, v12
  s_nop 7
  v_mul_f32 v176, v176, v156
  v_mul_f32 v177, v177, v156
  v_mul_f32 v178, v178, v156
  v_mul_f32 v179, v179, v156
  v_cvt_pk_bf16_f32 v160, v176, v177
  v_cvt_pk_bf16_f32 v161, v178, v179
  ds_write_b64 v12, v[160:161] offset:0
  v_mul_f32 v180, v180, v157
  v_mul_f32 v181, v181, v157
  v_mul_f32 v182, v182, v157
  v_mul_f32 v183, v183, v157
  v_cvt_pk_bf16_f32 v162, v180, v181
  v_cvt_pk_bf16_f32 v163, v182, v183
  ds_write_b64 v12, v[162:163] offset:2304
  v_mul_f32 v184, v184, v158
  v_mul_f32 v185, v185, v158
  v_mul_f32 v186, v186, v158
  v_mul_f32 v187, v187, v158
  v_cvt_pk_bf16_f32 v164, v184, v185
  v_cvt_pk_bf16_f32 v165, v186, v187
  ds_write_b64 v12, v[164:165] offset:4608
  v_mul_f32 v188, v188, v159
  v_mul_f32 v189, v189, v159
  v_mul_f32 v190, v190, v159
  v_mul_f32 v191, v191, v159
  v_cvt_pk_bf16_f32 v166, v188, v189
  v_cvt_pk_bf16_f32 v167, v190, v191
  ds_write_b64 v12, v[166:167] offset:6912
  v_lshrrev_b32 v13, 3, v1
  v_mul_u32_u24 v13, 144, v13
  v_and_b32 v15, 7, v1
  v_lshl_add_u32 v13, v15, 4, v13
  s_mul_i32 s3, s28, 2304
  v_add_u32 v13, s3, v13
  v_lshrrev_b32 v14, 3, v1
  s_lshl_b32 s3, s29, 6
  s_lshl_b32 s31, s28, 4
  s_add_u32 s3, s3, s31
  v_add_u32 v14, s3, v14
  v_lshlrev_b32 v14, 10, v14
  v_and_b32 v15, 7, v1
  v_lshl_add_u32 v14, v15, 4, v14
  s_lshl_b32 s3, s30, 7
  v_add_u32 v14, s3, v14
  s_waitcnt lgkmcnt(0)
  s_barrier
  ds_read_b128 v[176:179], v13
  ds_read_b128 v[180:183], v13 offset:1152
  s_mov_b32 s3, 8192
  s_waitcnt lgkmcnt(1)
  buffer_store_dwordx4 v[176:179], v14, s[16:19], 0 offen sc1
  s_waitcnt lgkmcnt(0)
  buffer_store_dwordx4 v[180:183], v14, s[16:19], s3 offen sc1
  s_mov_b32 s8, s4
  s_mov_b32 s9, s5
  s_mov_b32 s10, 0x200000
  s_mov_b32 s11, 0x00020000
  s_mov_b32 s16, s44
  s_mov_b32 s17, s45
  s_mov_b32 s18, 0x200000
  s_mov_b32 s19, 0x00020000
  s_add_u32 s84, s4, 0x200000
  s_addc_u32 s85, s5, 0
  s_mov_b32 s86, 0x200000
  s_mov_b32 s87, 0x00020000
  s_add_u32 s88, s4, 0xc00000
  s_addc_u32 s89, s5, 0
  s_mov_b32 s90, 0x20000
  s_mov_b32 s91, 0x00020000
  s_lshl_b32 s32, s28, 15
  s_add_u32 s31, s28, 0
  s_and_b32 s31, s31, 3
  s_lshl_b32 s48, s31, 14
  s_add_u32 s31, s28, 1
  s_and_b32 s31, s31, 3
  s_lshl_b32 s49, s31, 14
  s_add_u32 s31, s28, 2
  s_and_b32 s31, s31, 3
  s_lshl_b32 s50, s31, 14
  s_add_u32 s31, s28, 3
  s_and_b32 s31, s31, 3
  s_lshl_b32 s51, s31, 14
  s_lshl_b32 s31, s29, 6
  v_lshrrev_b32 v10, 3, v1
  v_add_u32 v11, s31, v10
  v_lshlrev_b32 v2, 10, v11
  s_lshl_b32 s3, s28, 8
  v_add_u32 v2, s3, v2
  v_and_b32 v10, 7, v1
  v_lshrrev_b32 v12, 4, v1
  v_xor_b32 v10, v10, v12
  v_xor_b32 v11, 4, v10
  v_add_u32 v3, 8192, v2
  v_lshl_add_u32 v3, v11, 4, v3
  v_lshl_add_u32 v2, v10, 4, v2
  v_and_b32 v11, 15, v1
  v_lshrrev_b32 v10, 1, v11
  v_xor_b32 v10, v10, v12
  v_lshlrev_b32 v13, 7, v11
  v_add_u32 v13, s32, v13
  v_lshl_add_u32 v13, v10, 4, v13
  v_xor_b32 v14, 64, v13
  s_lshl_b32 s3, s28, 4
  s_add_u32 s3, s3, s31
  v_add_u32 v11, s3, v11
  v_lshlrev_b32 v4, 10, v11
  v_lshl_add_u32 v4, v12, 3, v4
  s_lshl_b32 s3, s30, 7
  v_add_u32 v4, s3, v4
  v_lshrrev_b32 v10, 3, v1
  s_lshl_b32 s33, s28, 4
  s_add_u32 s33, s33, s31
  v_add_u32 v156, s33, v10
  v_lshlrev_b32 v156, 10, v156
  v_and_b32 v11, 7, v1
  v_lshl_add_u32 v156, v11, 4, v156
  v_add_u32 v156, s3, v156
  v_add_u32 v157, 8192, v156
  s_lshl_b32 s33, s28, 11
  s_add_u32 s33, s33, 131072
  s_add_u32 m0, s33, 0
  s_nop 0
  buffer_load_dwordx4 v156, s[16:19], 0 offen lds
  s_add_u32 m0, s33, 1024
  s_nop 0
  buffer_load_dwordx4 v157, s[16:19], 0 offen lds
  v_mul_u32_u24 v159, 144, v10
  v_lshl_add_u32 v159, v11, 4, v159
  v_add_u32 v159, s32, v159
  v_and_b32 v10, 15, v1
  v_mul_u32_u24 v158, 144, v10
  v_lshl_add_u32 v158, v12, 3, v158
  v_add_u32 v158, s32, v158
  v_lshlrev_b32 v160, 7, v10
  v_lshl_add_u32 v160, v12, 3, v160
  v_add_u32 v160, s33, v160
  v_lshrrev_b32 v10, 4, v1
  v_bfe_u32 v11, v1, 2, 2
  v_lshl_add_u32 v12, v10, 3, v11
  v_lshlrev_b32 v12, 7, v12
  v_add_u32 v12, s32, v12
  v_and_b32 v5, 3, v1
  v_lshl_add_u32 v12, v5, 3, v12
  v_bfe_u32 v11, v1, 3, 1
  v_bfe_u32 v10, v1, 4, 1
  v_lshl_or_b32 v10, v10, 1, v11
  v_xor_b32 v11, 0, v10
  v_lshl_add_u32 v5, v11, 5, v12
  v_xor_b32 v11, 1, v10
  v_lshl_add_u32 v6, v11, 5, v12
  v_xor_b32 v11, 2, v10
  v_lshl_add_u32 v7, v11, 5, v12
  v_xor_b32 v11, 3, v10
  v_lshl_add_u32 v8, v11, 5, v12
  s_waitcnt vmcnt(0)
  s_barrier
  s_barrier
  ds_read_b64 v[16:17], v160 offset:0
  ds_read_b64 v[18:19], v160 offset:32
  ds_read_b64 v[20:21], v160 offset:64
  ds_read_b64 v[22:23], v160 offset:96
  s_add_u32 s33, s48, 0
  s_add_u32 m0, s32, 0
  s_nop 0
  buffer_load_dwordx4 v2, s[8:11], s33 offen sc1 lds
  s_add_u32 m0, s32, 1024
  s_nop 0
  buffer_load_dwordx4 v3, s[8:11], s33 offen sc1 lds
  s_add_u32 s33, s49, 0
  s_add_u32 m0, s32, 2048
  s_nop 0
  buffer_load_dwordx4 v2, s[8:11], s33 offen sc1 lds
  s_add_u32 m0, s32, 3072
  s_nop 0
  buffer_load_dwordx4 v3, s[8:11], s33 offen sc1 lds
  s_add_u32 s33, s50, 0
  s_add_u32 m0, s32, 4096
  s_nop 0
  buffer_load_dwordx4 v2, s[8:11], s33 offen sc1 lds
  s_add_u32 m0, s32, 5120
  s_nop 0
  buffer_load_dwordx4 v3, s[8:11], s33 offen sc1 lds
  s_add_u32 s33, s51, 0
  s_add_u32 m0, s32, 6144
  s_nop 0
  buffer_load_dwordx4 v2, s[8:11], s33 offen sc1 lds
  s_add_u32 m0, s32, 7168
  s_nop 0
  buffer_load_dwordx4 v3, s[8:11], s33 offen sc1 lds
  s_add_u32 s33, s48, 128
  s_add_u32 m0, s32, 8192
  s_nop 0
  buffer_load_dwordx4 v2, s[8:11], s33 offen sc1 lds
  s_add_u32 m0, s32, 9216
  s_nop 0
  buffer_load_dwordx4 v3, s[8:11], s33 offen sc1 lds
  s_add_u32 s33, s49, 128
  s_add_u32 m0, s32, 10240
  s_nop 0
  buffer_load_dwordx4 v2, s[8:11], s33 offen sc1 lds
  s_add_u32 m0, s32, 11264
  s_nop 0
  buffer_load_dwordx4 v3, s[8:11], s33 offen sc1 lds
  s_add_u32 s33, s50, 128
  s_add_u32 m0, s32, 12288
  s_nop 0
  buffer_load_dwordx4 v2, s[8:11], s33 offen sc1 lds
  s_add_u32 m0, s32, 13312
  s_nop 0
  buffer_load_dwordx4 v3, s[8:11], s33 offen sc1 lds
  s_add_u32 s33, s51, 128
  s_add_u32 m0, s32, 14336
  s_nop 0
  buffer_load_dwordx4 v2, s[8:11], s33 offen sc1 lds
  s_add_u32 m0, s32, 15360
  s_nop 0
  buffer_load_dwordx4 v3, s[8:11], s33 offen sc1 lds
  s_waitcnt vmcnt(8)
  ds_read_b64_tr_b16 v[88:89], v5 offset:16384
  ds_read_b64_tr_b16 v[90:91], v5 offset:16896
  ds_read_b128 v[120:123], v13 offset:0
  ds_read_b64_tr_b16 v[92:93], v6 offset:16384
  ds_read_b64_tr_b16 v[94:95], v6 offset:16896
  ds_read_b128 v[124:127], v13 offset:2048
  ds_read_b64_tr_b16 v[96:97], v7 offset:16384
  ds_read_b64_tr_b16 v[98:99], v7 offset:16896
  ds_read_b128 v[128:131], v13 offset:4096
  ds_read_b64_tr_b16 v[100:101], v8 offset:16384
  ds_read_b64_tr_b16 v[102:103], v8 offset:16896
  ds_read_b128 v[132:135], v13 offset:6144
  s_waitcnt lgkmcnt(0)
  v_mfma_f32_16x16x32_bf16 v[24:27], v[88:91], v[120:123], 0
  ds_read_b64_tr_b16 v[104:105], v5 offset:20480
  v_mfma_f32_16x16x32_bf16 v[40:43], v[92:95], v[120:123], 0
  ds_read_b64_tr_b16 v[106:107], v5 offset:20992
  v_mfma_f32_16x16x32_bf16 v[56:59], v[96:99], v[120:123], 0
  ds_read_b128 v[136:139], v14 offset:0
  v_mfma_f32_16x16x32_bf16 v[72:75], v[100:103], v[120:123], 0
  ds_read_b64_tr_b16 v[108:109], v6 offset:20480
  v_mfma_f32_16x16x32_bf16 v[28:31], v[88:91], v[124:127], 0
  ds_read_b64_tr_b16 v[110:111], v6 offset:20992
  v_mfma_f32_16x16x32_bf16 v[44:47], v[92:95], v[124:127], 0
  ds_read_b128 v[140:143], v14 offset:2048
  v_mfma_f32_16x16x32_bf16 v[60:63], v[96:99], v[124:127], 0
  ds_read_b64_tr_b16 v[112:113], v7 offset:20480
  v_mfma_f32_16x16x32_bf16 v[76:79], v[100:103], v[124:127], 0
  ds_read_b64_tr_b16 v[114:115], v7 offset:20992
  v_mfma_f32_16x16x32_bf16 v[32:35], v[88:91], v[128:131], 0
  ds_read_b128 v[144:147], v14 offset:4096
  v_mfma_f32_16x16x32_bf16 v[48:51], v[92:95], v[128:131], 0
  ds_read_b64_tr_b16 v[116:117], v8 offset:20480
  v_mfma_f32_16x16x32_bf16 v[64:67], v[96:99], v[128:131], 0
  ds_read_b64_tr_b16 v[118:119], v8 offset:20992
  v_mfma_f32_16x16x32_bf16 v[80:83], v[100:103], v[128:131], 0
  ds_read_b128 v[148:151], v14 offset:6144
  v_mfma_f32_16x16x32_bf16 v[36:39], v[88:91], v[132:135], 0
  v_mfma_f32_16x16x32_bf16 v[52:55], v[92:95], v[132:135], 0
  v_mfma_f32_16x16x32_bf16 v[68:71], v[96:99], v[132:135], 0
  v_mfma_f32_16x16x32_bf16 v[84:87], v[100:103], v[132:135], 0
  s_waitcnt lgkmcnt(0)
  s_waitcnt vmcnt(0)
  s_cmp_ge_u32 s28, 2
  s_cselect_b32 s6, s22, s20
  s_cselect_b32 s7, s23, s21
  s_mov_b32 s12, s6
  s_mov_b32 s13, s7
  s_mov_b32 s14, 0x1c0000
  s_mov_b32 s15, 0x00020000
  s_lshr_b32 s3, s2, 3
  s_lshl_b32 s3, s3, 1
  s_and_b32 s31, s28, 1
  s_add_u32 s3, s3, s31
  s_mul_i32 s3, s3, 28672
  s_and_b32 s31, s2, 3
  s_mul_i32 s31, s31, 896
  s_add_u32 s3, s3, s31
  v_lshrrev_b32 v10, 3, v1
  v_mul_u32_u24 v10, 3584, v10
  v_and_b32 v11, 7, v1
  v_min_u32 v11, 6, v11
  v_lshl_add_u32 v10, v11, 7, v10
  buffer_load_dword v200, v10, s[12:15], s3 offen
  v_mfma_f32_16x16x32_bf16 v[24:27], v[104:107], v[136:139], v[24:27]
  ds_read_b64_tr_b16 v[88:89], v5 offset:24576
  v_mfma_f32_16x16x32_bf16 v[40:43], v[108:111], v[136:139], v[40:43]
  ds_read_b64_tr_b16 v[90:91], v5 offset:25088
  v_mfma_f32_16x16x32_bf16 v[56:59], v[112:115], v[136:139], v[56:59]
  ds_read_b128 v[120:123], v13 offset:8192
  v_mfma_f32_16x16x32_bf16 v[72:75], v[116:119], v[136:139], v[72:75]
  ds_read_b64_tr_b16 v[92:93], v6 offset:24576
  v_mfma_f32_16x16x32_bf16 v[28:31], v[104:107], v[140:143], v[28:31]
  ds_read_b64_tr_b16 v[94:95], v6 offset:25088
  v_mfma_f32_16x16x32_bf16 v[44:47], v[108:111], v[140:143], v[44:47]
  ds_read_b128 v[124:127], v13 offset:10240
  v_mfma_f32_16x16x32_bf16 v[60:63], v[112:115], v[140:143], v[60:63]
  ds_read_b64_tr_b16 v[96:97], v7 offset:24576
  v_mfma_f32_16x16x32_bf16 v[76:79], v[116:119], v[140:143], v[76:79]
  ds_read_b64_tr_b16 v[98:99], v7 offset:25088
  v_mfma_f32_16x16x32_bf16 v[32:35], v[104:107], v[144:147], v[32:35]
  ds_read_b128 v[128:131], v13 offset:12288
  v_mfma_f32_16x16x32_bf16 v[48:51], v[108:111], v[144:147], v[48:51]
  ds_read_b64_tr_b16 v[100:101], v8 offset:24576
  v_mfma_f32_16x16x32_bf16 v[64:67], v[112:115], v[144:147], v[64:67]
  ds_read_b64_tr_b16 v[102:103], v8 offset:25088
  v_mfma_f32_16x16x32_bf16 v[80:83], v[116:119], v[144:147], v[80:83]
  ds_read_b128 v[132:135], v13 offset:14336
  v_mfma_f32_16x16x32_bf16 v[36:39], v[104:107], v[148:151], v[36:39]
  v_mfma_f32_16x16x32_bf16 v[52:55], v[108:111], v[148:151], v[52:55]
  v_mfma_f32_16x16x32_bf16 v[68:71], v[112:115], v[148:151], v[68:71]
  v_mfma_f32_16x16x32_bf16 v[84:87], v[116:119], v[148:151], v[84:87]
  s_waitcnt lgkmcnt(0)
  v_mfma_f32_16x16x32_bf16 v[24:27], v[88:91], v[120:123], v[24:27]
  ds_read_b64_tr_b16 v[104:105], v5 offset:28672
  v_mfma_f32_16x16x32_bf16 v[40:43], v[92:95], v[120:123], v[40:43]
  ds_read_b64_tr_b16 v[106:107], v5 offset:29184
  v_mfma_f32_16x16x32_bf16 v[56:59], v[96:99], v[120:123], v[56:59]
  ds_read_b128 v[136:139], v14 offset:8192
  v_mfma_f32_16x16x32_bf16 v[72:75], v[100:103], v[120:123], v[72:75]
  ds_read_b64_tr_b16 v[108:109], v6 offset:28672
  v_mfma_f32_16x16x32_bf16 v[28:31], v[88:91], v[124:127], v[28:31]
  ds_read_b64_tr_b16 v[110:111], v6 offset:29184
  v_mfma_f32_16x16x32_bf16 v[44:47], v[92:95], v[124:127], v[44:47]
  ds_read_b128 v[140:143], v14 offset:10240
  v_mfma_f32_16x16x32_bf16 v[60:63], v[96:99], v[124:127], v[60:63]
  ds_read_b64_tr_b16 v[112:113], v7 offset:28672
  v_mfma_f32_16x16x32_bf16 v[76:79], v[100:103], v[124:127], v[76:79]
  ds_read_b64_tr_b16 v[114:115], v7 offset:29184
  v_mfma_f32_16x16x32_bf16 v[32:35], v[88:91], v[128:131], v[32:35]
  ds_read_b128 v[144:147], v14 offset:12288
  v_mfma_f32_16x16x32_bf16 v[48:51], v[92:95], v[128:131], v[48:51]
  ds_read_b64_tr_b16 v[116:117], v8 offset:28672
  v_mfma_f32_16x16x32_bf16 v[64:67], v[96:99], v[128:131], v[64:67]
  ds_read_b64_tr_b16 v[118:119], v8 offset:29184
  v_mfma_f32_16x16x32_bf16 v[80:83], v[100:103], v[128:131], v[80:83]
  ds_read_b128 v[148:151], v14 offset:14336
  v_mfma_f32_16x16x32_bf16 v[36:39], v[88:91], v[132:135], v[36:39]
  v_mfma_f32_16x16x32_bf16 v[52:55], v[92:95], v[132:135], v[52:55]
  v_mfma_f32_16x16x32_bf16 v[68:71], v[96:99], v[132:135], v[68:71]
  v_mfma_f32_16x16x32_bf16 v[84:87], v[100:103], v[132:135], v[84:87]
  s_waitcnt lgkmcnt(0)
  v_mfma_f32_16x16x32_bf16 v[24:27], v[104:107], v[136:139], v[24:27]
  v_mfma_f32_16x16x32_bf16 v[40:43], v[108:111], v[136:139], v[40:43]
  v_mfma_f32_16x16x32_bf16 v[56:59], v[112:115], v[136:139], v[56:59]
  v_mfma_f32_16x16x32_bf16 v[72:75], v[116:119], v[136:139], v[72:75]
  v_mfma_f32_16x16x32_bf16 v[28:31], v[104:107], v[140:143], v[28:31]
  v_mfma_f32_16x16x32_bf16 v[44:47], v[108:111], v[140:143], v[44:47]
  v_mfma_f32_16x16x32_bf16 v[60:63], v[112:115], v[140:143], v[60:63]
  v_mfma_f32_16x16x32_bf16 v[76:79], v[116:119], v[140:143], v[76:79]
  v_mfma_f32_16x16x32_bf16 v[32:35], v[104:107], v[144:147], v[32:35]
  v_mfma_f32_16x16x32_bf16 v[48:51], v[108:111], v[144:147], v[48:51]
  v_mfma_f32_16x16x32_bf16 v[64:67], v[112:115], v[144:147], v[64:67]
  v_mfma_f32_16x16x32_bf16 v[80:83], v[116:119], v[144:147], v[80:83]
  v_mfma_f32_16x16x32_bf16 v[36:39], v[104:107], v[148:151], v[36:39]
  v_mfma_f32_16x16x32_bf16 v[52:55], v[108:111], v[148:151], v[52:55]
  v_mfma_f32_16x16x32_bf16 v[68:71], v[112:115], v[148:151], v[68:71]
  v_mfma_f32_16x16x32_bf16 v[84:87], v[116:119], v[148:151], v[84:87]
  v_lshlrev_b32 v10, 4, v1
  v_add_u32 v11, s32, v10
  s_nop 7
  s_nop 3
  ds_write_b128 v11, v[28:31] offset:0
  ds_write_b128 v11, v[44:47] offset:1024
  ds_write_b128 v11, v[60:63] offset:2048
  ds_write_b128 v11, v[76:79] offset:3072
  ds_write_b128 v11, v[32:35] offset:4096
  ds_write_b128 v11, v[48:51] offset:5120
  ds_write_b128 v11, v[64:67] offset:6144
  ds_write_b128 v11, v[80:83] offset:7168
  ds_write_b128 v11, v[36:39] offset:8192
  ds_write_b128 v11, v[52:55] offset:9216
  ds_write_b128 v11, v[68:71] offset:10240
  ds_write_b128 v11, v[84:87] offset:11264
  v_lshlrev_b32 v136, 16, v16
  v_and_b32 v137, 0xffff0000, v16
  v_lshlrev_b32 v138, 16, v17
  v_and_b32 v139, 0xffff0000, v17
  v_lshlrev_b32 v140, 16, v18
  v_and_b32 v141, 0xffff0000, v18
  v_lshlrev_b32 v142, 16, v19
  v_and_b32 v143, 0xffff0000, v19
  v_lshlrev_b32 v144, 16, v20
  v_and_b32 v145, 0xffff0000, v20
  v_lshlrev_b32 v146, 16, v21
  v_and_b32 v147, 0xffff0000, v21
  v_lshlrev_b32 v148, 16, v22
  v_and_b32 v149, 0xffff0000, v22
  v_lshlrev_b32 v150, 16, v23
  v_and_b32 v151, 0xffff0000, v23
  v_add_f32 v136, v136, v24
  v_add_f32 v137, v137, v25
  v_add_f32 v138, v138, v26
  v_add_f32 v139, v139, v27
  v_add_f32 v140, v140, v40
  v_add_f32 v141, v141, v41
  v_add_f32 v142, v142, v42
  v_add_f32 v143, v143, v43
  v_add_f32 v144, v144, v56
  v_add_f32 v145, v145, v57
  v_add_f32 v146, v146, v58
  v_add_f32 v147, v147, v59
  v_add_f32 v148, v148, v72
  v_add_f32 v149, v149, v73
  v_add_f32 v150, v150, v74
  v_add_f32 v151, v151, v75
  s_waitcnt lgkmcnt(0)
  s_barrier
  s_sub_u32 s3, s28, 1
  s_and_b32 s3, s3, 3
  s_lshl_b32 s3, s3, 15
  v_add_u32 v11, s3, v10
  ds_read_b128 v[88:91], v11 offset:0
  ds_read_b128 v[92:95], v11 offset:1024
  ds_read_b128 v[96:99], v11 offset:2048
  ds_read_b128 v[100:103], v11 offset:3072
  s_sub_u32 s3, s28, 2
  s_and_b32 s3, s3, 3
  s_lshl_b32 s3, s3, 15
  v_add_u32 v11, s3, v10
  ds_read_b128 v[104:107], v11 offset:4096
  ds_read_b128 v[108:111], v11 offset:5120
  ds_read_b128 v[112:115], v11 offset:6144
  ds_read_b128 v[116:119], v11 offset:7168
  s_sub_u32 s3, s28, 3
  s_and_b32 s3, s3, 3
  s_lshl_b32 s3, s3, 15
  v_add_u32 v11, s3, v10
  ds_read_b128 v[120:123], v11 offset:8192
  ds_read_b128 v[124:127], v11 offset:9216
  ds_read_b128 v[128:131], v11 offset:10240
  ds_read_b128 v[132:135], v11 offset:11264
  s_waitcnt lgkmcnt(8)
  v_add_f32 v136, v136, v88
  v_add_f32 v137, v137, v89
  v_add_f32 v138, v138, v90
  v_add_f32 v139, v139, v91
  v_add_f32 v140, v140, v92
  v_add_f32 v141, v141, v93
  v_add_f32 v142, v142, v94
  v_add_f32 v143, v143, v95
  v_add_f32 v144, v144, v96
  v_add_f32 v145, v145, v97
  v_add_f32 v146, v146, v98
  v_add_f32 v147, v147, v99
  v_add_f32 v148, v148, v100
  v_add_f32 v149, v149, v101
  v_add_f32 v150, v150, v102
  v_add_f32 v151, v151, v103
  s_waitcnt lgkmcnt(4)
  v_add_f32 v136, v136, v104
  v_add_f32 v137, v137, v105
  v_add_f32 v138, v138, v106
  v_add_f32 v139, v139, v107
  v_add_f32 v140, v140, v108
  v_add_f32 v141, v141, v109
  v_add_f32 v142, v142, v110
  v_add_f32 v143, v143, v111
  v_add_f32 v144, v144, v112
  v_add_f32 v145, v145, v113
  v_add_f32 v146, v146, v114
  v_add_f32 v147, v147, v115
  v_add_f32 v148, v148, v116
  v_add_f32 v149, v149, v117
  v_add_f32 v150, v150, v118
  v_add_f32 v151, v151, v119
  s_waitcnt lgkmcnt(0)
  v_add_f32 v136, v136, v120
  v_add_f32 v137, v137, v121
  v_add_f32 v138, v138, v122
  v_add_f32 v139, v139, v123
  v_add_f32 v140, v140, v124
  v_add_f32 v141, v141, v125
  v_add_f32 v142, v142, v126
  v_add_f32 v143, v143, v127
  v_add_f32 v144, v144, v128
  v_add_f32 v145, v145, v129
  v_add_f32 v146, v146, v130
  v_add_f32 v147, v147, v131
  v_add_f32 v148, v148, v132
  v_add_f32 v149, v149, v133
  v_add_f32 v150, v150, v134
  v_add_f32 v151, v151, v135
  v_cvt_pk_bf16_f32 v88, v136, v137
  v_cvt_pk_bf16_f32 v89, v138, v139
  v_cvt_pk_bf16_f32 v90, v140, v141
  v_cvt_pk_bf16_f32 v91, v142, v143
  v_cvt_pk_bf16_f32 v92, v144, v145
  v_cvt_pk_bf16_f32 v93, v146, v147
  v_cvt_pk_bf16_f32 v94, v148, v149
  v_cvt_pk_bf16_f32 v95, v150, v151
  ds_write_b64 v158, v[88:89] offset:12288
  ds_write_b64 v158, v[90:91] offset:12320
  ds_write_b64 v158, v[92:93] offset:12352
  ds_write_b64 v158, v[94:95] offset:12384
  s_waitcnt lgkmcnt(0)
  ds_read_b128 v[136:139], v159 offset:12288
  ds_read_b128 v[140:143], v159 offset:13440
  s_waitcnt lgkmcnt(1)
  buffer_store_dwordx4 v[136:139], v156, s[84:87], 0 offen sc1
  s_waitcnt lgkmcnt(0)
  buffer_store_dwordx4 v[140:143], v157, s[84:87], 0 offen sc1
  v_mov_b32 v96, 0
  v_mov_b32 v97, 0
  v_lshlrev_b32 v98, 16, v88
  v_and_b32 v99, 0xffff0000, v88
  v_add_f32 v96, v96, v98
  v_fmac_f32 v97, v98, v98
  v_add_f32 v96, v96, v99
  v_fmac_f32 v97, v99, v99
  v_lshlrev_b32 v98, 16, v89
  v_and_b32 v99, 0xffff0000, v89
  v_add_f32 v96, v96, v98
  v_fmac_f32 v97, v98, v98
  v_add_f32 v96, v96, v99
  v_fmac_f32 v97, v99, v99
  v_lshlrev_b32 v98, 16, v90
  v_and_b32 v99, 0xffff0000, v90
  v_add_f32 v96, v96, v98
  v_fmac_f32 v97, v98, v98
  v_add_f32 v96, v96, v99
  v_fmac_f32 v97, v99, v99
  v_lshlrev_b32 v98, 16, v91
  v_and_b32 v99, 0xffff0000, v91
  v_add_f32 v96, v96, v98
  v_fmac_f32 v97, v98, v98
  v_add_f32 v96, v96, v99
  v_fmac_f32 v97, v99, v99
  v_lshlrev_b32 v98, 16, v92
  v_and_b32 v99, 0xffff0000, v92
  v_add_f32 v96, v96, v98
  v_fmac_f32 v97, v98, v98
  v_add_f32 v96, v96, v99
  v_fmac_f32 v97, v99, v99
  v_lshlrev_b32 v98, 16, v93
  v_and_b32 v99, 0xffff0000, v93
  v_add_f32 v96, v96, v98
  v_fmac_f32 v97, v98, v98
  v_add_f32 v96, v96, v99
  v_fmac_f32 v97, v99, v99
  v_lshlrev_b32 v98, 16, v94
  v_and_b32 v99, 0xffff0000, v94
  v_add_f32 v96, v96, v98
  v_fmac_f32 v97, v98, v98
  v_add_f32 v96, v96, v99
  v_fmac_f32 v97, v99, v99
  v_lshlrev_b32 v98, 16, v95
  v_and_b32 v99, 0xffff0000, v95
  v_add_f32 v96, v96, v98
  v_fmac_f32 v97, v98, v98
  v_add_f32 v96, v96, v99
  v_fmac_f32 v97, v99, v99
  v_mov_b32 v98, v96
  v_mov_b32 v99, v97
  s_nop 1
  v_permlane32_swap_b32 v96, v98
  v_permlane32_swap_b32 v97, v99
  v_add_f32 v96, v96, v98
  v_add_f32 v97, v97, v99
  v_mov_b32 v98, v96
  v_mov_b32 v99, v97
  s_nop 1
  v_permlane16_swap_b32 v96, v98
  v_permlane16_swap_b32 v97, v99
  v_add_f32 v96, v96, v98
  v_add_f32 v97, v97, v99
  s_lshl_b32 s3, s29, 3
  s_add_u32 s3, s3, s30
  s_lshl_b32 s3, s3, 9
  s_lshl_b32 s31, s28, 7
  s_add_u32 s3, s3, s31
  v_lshlrev_b32 v98, 3, v1
  v_add_u32 v98, s3, v98
  v_cmp_gt_u32 vcc, 16, v1
  s_and_saveexec_b64 s[34:35], vcc
  buffer_store_dwordx2 v[96:97], v98, s[88:91], 0 offen sc1
  s_mov_b64 exec, s[34:35]
  s_waitcnt vmcnt(0)
  s_barrier
  s_branch k3_kernel

k3_kernel:
  s_cmp_ge_u32 s2, 256
  s_cbranch_scc1 k3_kernel_end
  s_load_dwordx2 s[4:5], s[0:1], 72
  s_load_dwordx4 s[44:47], s[0:1], 32
  s_load_dwordx2 s[48:49], s[0:1], 48
  v_lshrrev_b32 v2, 6, v0
  v_and_b32 v1, 63, v0
  v_readfirstlane_b32 s28, v2
  s_and_b32 s3, s2, 7
  s_lshr_b32 s31, s2, 3
  s_lshr_b32 s29, s3, 2
  s_lshl_b32 s29, s29, 3
  s_lshr_b32 s30, s31, 2
  s_add_u32 s29, s29, s30
  s_and_b32 s30, s3, 3
  s_lshl_b32 s30, s30, 2
  s_and_b32 s31, s31, 3
  s_add_u32 s30, s30, s31
  s_lshr_b32 s3, s2, 5
  s_lshl_b32 s38, s31, 1
  s_add_u32 s38, s38, s3
  s_and_b32 s38, s38, 7
  s_cmp_ge_u32 s28, 4
  s_cbranch_scc1 k3_kernel_loader
  s_lshl_b32 s3, s29, 7
  s_lshl_b32 s31, s28, 5
  s_add_u32 s3, s3, s31
  v_and_b32 v11, 31, v1
  v_add_u32 v8, s3, v11
  v_lshrrev_b32 v9, 5, v1
  v_lshrrev_b32 v10, 6, v8
  v_lshlrev_b32 v10, 12, v10
  v_and_b32 v3, 63, v8
  v_lshl_add_u32 v10, v3, 3, v10
  s_mov_b32 s3, 3584
  v_mul_lo_u32 v3, v8, s3
  v_lshl_add_u32 v3, v9, 4, v3
  s_mul_i32 s3, s30, 224
  v_add_u32 v3, s3, v3
  v_bfe_u32 v8, v1, 1, 3
  v_xor_b32 v8, v8, v9
  v_add_u32 v11, s31, v11
  v_lshlrev_b32 v11, 7, v11
  v_lshl_add_u32 v80, v8, 4, v11
  v_xor_b32 v81, 32, v80
  v_xor_b32 v82, 64, v80
  v_xor_b32 v83, 96, v80
  v_bfe_u32 v8, v1, 4, 1
  v_mul_u32_u24 v4, 14464, v8
  v_lshrrev_b32 v8, 5, v1
  v_bfe_u32 v9, v1, 2, 2
  v_lshl_add_u32 v8, v8, 3, v9
  v_mul_u32_u24 v8, 224, v8
  v_add_u32 v4, v4, v8
  v_and_b32 v8, 1, v1
  v_lshl_add_u32 v4, v8, 4, v4
  v_bfe_u32 v8, v1, 1, 1
  v_lshl_add_u32 v4, v8, 3, v4
  v_add_u32 v4, 65536, v4
  v_add_u32 v5, 57600, v4
  v_mov_b32 v84, 0xbdd2d3e8
  v_mov_b32 v86, 0xc0135761
  v_mov_b32 v88, 1.0
  v_mov_b32 v85, 0xbdd2d3e8
  v_mov_b32 v87, 0xc0135761
  v_mov_b32 v89, 1.0
  s_waitcnt lgkmcnt(0)
  s_add_u32 s16, s4, 0x400000
  s_addc_u32 s17, s5, 0
  s_mov_b32 s18, 0x700000
  s_mov_b32 s19, 0x00020000
  s_add_u32 s20, s4, 0xc00000
  s_addc_u32 s21, s5, 0
  s_mov_b32 s22, 0x20000
  s_mov_b32 s23, 0x00020000
  v_mov_b32 v96, 0
  v_mov_b32 v97, 0
  v_mov_b32 v98, 0
  v_mov_b32 v99, 0
  v_mov_b32 v100, 0
  v_mov_b32 v101, 0
  v_mov_b32 v102, 0
  v_mov_b32 v103, 0
  v_mov_b32 v104, 0
  v_mov_b32 v105, 0
  v_mov_b32 v106, 0
  v_mov_b32 v107, 0
  v_mov_b32 v108, 0
  v_mov_b32 v109, 0
  v_mov_b32 v110, 0
  v_mov_b32 v111, 0
  v_mov_b32 v112, 0
  v_mov_b32 v113, 0
  v_mov_b32 v114, 0
  v_mov_b32 v115, 0
  v_mov_b32 v116, 0
  v_mov_b32 v117, 0
  v_mov_b32 v118, 0
  v_mov_b32 v119, 0
  v_mov_b32 v120, 0
  v_mov_b32 v121, 0
  v_mov_b32 v122, 0
  v_mov_b32 v123, 0
  v_mov_b32 v124, 0
  v_mov_b32 v125, 0
  v_mov_b32 v126, 0
  v_mov_b32 v127, 0
  v_mov_b32 v128, 0
  v_mov_b32 v129, 0
  v_mov_b32 v130, 0
  v_mov_b32 v131, 0
  v_mov_b32 v132, 0
  v_mov_b32 v133, 0
  v_mov_b32 v134, 0
  v_mov_b32 v135, 0
  v_mov_b32 v136, 0
  v_mov_b32 v137, 0
  v_mov_b32 v138, 0
  v_mov_b32 v139, 0
  v_mov_b32 v140, 0
  v_mov_b32 v141, 0
  v_mov_b32 v142, 0
  v_mov_b32 v143, 0
  v_mov_b32 v144, 0
  v_mov_b32 v145, 0
  v_mov_b32 v146, 0
  v_mov_b32 v147, 0
  v_mov_b32 v148, 0
  v_mov_b32 v149, 0
  v_mov_b32 v150, 0
  v_mov_b32 v151, 0
  v_mov_b32 v152, 0
  v_mov_b32 v153, 0
  v_mov_b32 v154, 0
  v_mov_b32 v155, 0
  v_mov_b32 v156, 0
  v_mov_b32 v157, 0
  v_mov_b32 v158, 0
  v_mov_b32 v159, 0
  v_mov_b32 v160, 0
  v_mov_b32 v161, 0
  v_mov_b32 v162, 0
  v_mov_b32 v163, 0
  v_mov_b32 v164, 0
  v_mov_b32 v165, 0
  v_mov_b32 v166, 0
  v_mov_b32 v167, 0
  v_mov_b32 v168, 0
  v_mov_b32 v169, 0
  v_mov_b32 v170, 0
  v_mov_b32 v171, 0
  v_mov_b32 v172, 0
  v_mov_b32 v173, 0
  v_mov_b32 v174, 0
  v_mov_b32 v175, 0
  v_mov_b32 v176, 0
  v_mov_b32 v177, 0
  v_mov_b32 v178, 0
  v_mov_b32 v179, 0
  v_mov_b32 v180, 0
  v_mov_b32 v181, 0
  v_mov_b32 v182, 0
  v_mov_b32 v183, 0
  v_mov_b32 v184, 0
  v_mov_b32 v185, 0
  v_mov_b32 v186, 0
  v_mov_b32 v187, 0
  v_mov_b32 v188, 0
  v_mov_b32 v189, 0
  v_mov_b32 v190, 0
  v_mov_b32 v191, 0
  v_mov_b32 v192, 0
  v_mov_b32 v193, 0
  v_mov_b32 v194, 0
  v_mov_b32 v195, 0
  v_mov_b32 v196, 0
  v_mov_b32 v197, 0
  v_mov_b32 v198, 0
  v_mov_b32 v199, 0
  v_mov_b32 v200, 0
  v_mov_b32 v201, 0
  v_mov_b32 v202, 0
  v_mov_b32 v203, 0
  v_mov_b32 v204, 0
  v_mov_b32 v205, 0
  v_mov_b32 v206, 0
  v_mov_b32 v207, 0
  s_barrier
  buffer_load_dwordx2 v[24:25], v10, s[20:23], 0 offen offset:0 sc1
  buffer_load_dwordx2 v[26:27], v10, s[20:23], 0 offen offset:512 sc1
  buffer_load_dwordx2 v[28:29], v10, s[20:23], 0 offen offset:1024 sc1
  buffer_load_dwordx2 v[30:31], v10, s[20:23], 0 offen offset:1536 sc1
  buffer_load_dwordx2 v[32:33], v10, s[20:23], 0 offen offset:2048 sc1
  buffer_load_dwordx2 v[34:35], v10, s[20:23], 0 offen offset:2560 sc1
  buffer_load_dwordx2 v[36:37], v10, s[20:23], 0 offen offset:3072 sc1
  buffer_load_dwordx2 v[38:39], v10, s[20:23], 0 offen offset:3584 sc1
  s_waitcnt vmcnt(0)
  v_add_f32 v8, v24, v26
  v_add_f32 v9, v25, v27
  v_add_f32 v8, v8, v28
  v_add_f32 v9, v9, v29
  v_add_f32 v8, v8, v30
  v_add_f32 v9, v9, v31
  v_add_f32 v8, v8, v32
  v_add_f32 v9, v9, v33
  v_add_f32 v8, v8, v34
  v_add_f32 v9, v9, v35
  v_add_f32 v8, v8, v36
  v_add_f32 v9, v9, v37
  v_add_f32 v8, v8, v38
  v_add_f32 v9, v9, v39
  v_mul_f32 v8, 0x3b000000, v8
  v_mul_f32 v9, 0x3b000000, v9
  v_fma_f32 v9, -v8, v8, v9
  v_max_f32 v9, 0, v9
  v_add_f32 v9, 0x3727c5ac, v9
  v_rsq_f32 v6, v9
  s_nop 0
  v_mul_f32 v7, v8, v6
  v_sub_f32 v7, 0, v7
  v_mov_b32 v90, v6
  v_mov_b32 v91, v6
  v_mov_b32 v92, v7
  v_mov_b32 v93, v7
  v_add_u32 v5, 28800, v4
  v_add_u32 v20, 16384, v80
  v_add_u32 v21, 16384, v81
  s_mov_b32 s40, 1
  s_mov_b32 s41, 1
  s_mov_b32 s42, 0
  s_barrier
  ds_read_b128 v[208:211], v80
  s_waitcnt lgkmcnt(0)
  ds_read_b64_tr_b16 v[24:25], v4 offset:0
  ds_read_b64_tr_b16 v[26:27], v4 offset:896
  ds_read_b64_tr_b16 v[28:29], v4 offset:32
  ds_read_b64_tr_b16 v[30:31], v4 offset:928
  ds_read_b64_tr_b16 v[32:33], v4 offset:64
  ds_read_b64_tr_b16 v[34:35], v4 offset:960
  ds_read_b64_tr_b16 v[36:37], v4 offset:96
  ds_read_b64_tr_b16 v[38:39], v4 offset:992
  ds_read_b128 v[212:215], v81
  ds_read_b64_tr_b16 v[40:41], v4 offset:128
  ds_read_b64_tr_b16 v[42:43], v4 offset:1024
  ds_read_b64_tr_b16 v[44:45], v4 offset:160
  ds_read_b64_tr_b16 v[46:47], v4 offset:1056
  ds_read_b64_tr_b16 v[48:49], v4 offset:192
  ds_read_b64_tr_b16 v[50:51], v4 offset:1088
  v_lshlrev_b32 v8, 16, v208
  v_and_b32 v9, 0xffff0000, v208
  v_fma_f32 v8, v8, v6, v7
  v_fma_f32 v9, v9, v6, v7
  v_cvt_pk_bf16_f32 v12, v8, v9
  v_lshlrev_b32 v10, 16, v209
  v_and_b32 v11, 0xffff0000, v209
  v_fma_f32 v10, v10, v6, v7
  v_fma_f32 v11, v11, v6, v7
  v_cvt_pk_bf16_f32 v13, v10, v11
  v_lshlrev_b32 v8, 16, v210
  v_and_b32 v9, 0xffff0000, v210
  v_fma_f32 v8, v8, v6, v7
  v_fma_f32 v9, v9, v6, v7
  v_cvt_pk_bf16_f32 v14, v8, v9
  v_lshlrev_b32 v10, 16, v211
  v_and_b32 v11, 0xffff0000, v211
  v_fma_f32 v10, v10, v6, v7
  v_fma_f32 v11, v11, v6, v7
  v_cvt_pk_bf16_f32 v15, v10, v11
  s_nop 0
k3_kernel_loop:
  s_waitcnt lgkmcnt(11)
  v_mfma_f32_32x32x16_bf16 v[96:111], v[24:27], v[12:15], v[96:111]
  s_waitcnt lgkmcnt(6)
  ds_read_b64_tr_b16 v[52:53], v4 offset:3584
  ds_read_b64_tr_b16 v[54:55], v4 offset:4480
  v_lshlrev_b32 v8, 16, v212
  v_and_b32 v9, 0xffff0000, v212
  v_fma_f32 v8, v8, v6, v7
  v_mfma_f32_32x32x16_bf16 v[112:127], v[28:31], v[12:15], v[112:127]
  ds_read_b64_tr_b16 v[56:57], v4 offset:3616
  ds_read_b64_tr_b16 v[58:59], v4 offset:4512
  v_fma_f32 v9, v9, v6, v7
  v_cvt_pk_bf16_f32 v16, v8, v9
  v_lshlrev_b32 v10, 16, v213
  v_mfma_f32_32x32x16_bf16 v[128:143], v[32:35], v[12:15], v[128:143]
  ds_read_b64_tr_b16 v[60:61], v4 offset:3648
  ds_read_b64_tr_b16 v[62:63], v4 offset:4544
  v_and_b32 v11, 0xffff0000, v213
  v_fma_f32 v10, v10, v6, v7
  v_fma_f32 v11, v11, v6, v7
  v_mfma_f32_32x32x16_bf16 v[144:159], v[36:39], v[12:15], v[144:159]
  ds_read_b64_tr_b16 v[64:65], v4 offset:3680
  ds_read_b64_tr_b16 v[66:67], v4 offset:4576
  ds_read_b128 v[208:211], v82
  v_cvt_pk_bf16_f32 v17, v10, v11
  v_lshlrev_b32 v8, 16, v214
  v_and_b32 v9, 0xffff0000, v214
  s_waitcnt lgkmcnt(11)
  v_mfma_f32_32x32x16_bf16 v[160:175], v[40:43], v[12:15], v[160:175]
  ds_read_b64_tr_b16 v[68:69], v4 offset:3712
  ds_read_b64_tr_b16 v[70:71], v4 offset:4608
  v_fma_f32 v8, v8, v6, v7
  v_fma_f32 v9, v9, v6, v7
  v_cvt_pk_bf16_f32 v18, v8, v9
  v_mfma_f32_32x32x16_bf16 v[176:191], v[44:47], v[12:15], v[176:191]
  ds_read_b64_tr_b16 v[72:73], v4 offset:3744
  ds_read_b64_tr_b16 v[74:75], v4 offset:4640
  v_lshlrev_b32 v10, 16, v215
  v_and_b32 v11, 0xffff0000, v215
  v_fma_f32 v10, v10, v6, v7
  s_waitcnt lgkmcnt(13)
  v_mfma_f32_32x32x16_bf16 v[192:207], v[48:51], v[12:15], v[192:207]
  ds_read_b64_tr_b16 v[76:77], v4 offset:3776
  ds_read_b64_tr_b16 v[78:79], v4 offset:4672
  v_fma_f32 v11, v11, v6, v7
  v_cvt_pk_bf16_f32 v19, v10, v11
  s_nop 0
  s_waitcnt lgkmcnt(11)
  v_mfma_f32_32x32x16_bf16 v[96:111], v[52:55], v[16:19], v[96:111]
  s_waitcnt lgkmcnt(6)
  ds_read_b64_tr_b16 v[24:25], v4 offset:7168
  ds_read_b64_tr_b16 v[26:27], v4 offset:8064
  v_lshlrev_b32 v8, 16, v208
  v_and_b32 v9, 0xffff0000, v208
  v_fma_f32 v8, v8, v6, v7
  v_mfma_f32_32x32x16_bf16 v[112:127], v[56:59], v[16:19], v[112:127]
  ds_read_b64_tr_b16 v[28:29], v4 offset:7200
  ds_read_b64_tr_b16 v[30:31], v4 offset:8096
  v_fma_f32 v9, v9, v6, v7
  v_cvt_pk_bf16_f32 v12, v8, v9
  v_lshlrev_b32 v10, 16, v209
  v_mfma_f32_32x32x16_bf16 v[128:143], v[60:63], v[16:19], v[128:143]
  ds_read_b64_tr_b16 v[32:33], v4 offset:7232
  ds_read_b64_tr_b16 v[34:35], v4 offset:8128
  v_and_b32 v11, 0xffff0000, v209
  v_fma_f32 v10, v10, v6, v7
  v_fma_f32 v11, v11, v6, v7
  v_mfma_f32_32x32x16_bf16 v[144:159], v[64:67], v[16:19], v[144:159]
  ds_read_b64_tr_b16 v[36:37], v4 offset:7264
  ds_read_b64_tr_b16 v[38:39], v4 offset:8160
  ds_read_b128 v[212:215], v83
  v_cvt_pk_bf16_f32 v13, v10, v11
  v_lshlrev_b32 v8, 16, v210
  v_and_b32 v9, 0xffff0000, v210
  s_waitcnt lgkmcnt(11)
  v_mfma_f32_32x32x16_bf16 v[160:175], v[68:71], v[16:19], v[160:175]
  ds_read_b64_tr_b16 v[40:41], v4 offset:7296
  ds_read_b64_tr_b16 v[42:43], v4 offset:8192
  v_fma_f32 v8, v8, v6, v7
  v_fma_f32 v9, v9, v6, v7
  v_cvt_pk_bf16_f32 v14, v8, v9
  v_mfma_f32_32x32x16_bf16 v[176:191], v[72:75], v[16:19], v[176:191]
  ds_read_b64_tr_b16 v[44:45], v4 offset:7328
  ds_read_b64_tr_b16 v[46:47], v4 offset:8224
  v_lshlrev_b32 v10, 16, v211
  v_and_b32 v11, 0xffff0000, v211
  v_fma_f32 v10, v10, v6, v7
  s_waitcnt lgkmcnt(13)
  v_mfma_f32_32x32x16_bf16 v[192:207], v[76:79], v[16:19], v[192:207]
  ds_read_b64_tr_b16 v[48:49], v4 offset:7360
  ds_read_b64_tr_b16 v[50:51], v4 offset:8256
  v_fma_f32 v11, v11, v6, v7
  v_cvt_pk_bf16_f32 v15, v10, v11
  s_nop 0
  s_waitcnt lgkmcnt(11)
  v_mfma_f32_32x32x16_bf16 v[96:111], v[24:27], v[12:15], v[96:111]
  s_waitcnt lgkmcnt(6)
  ds_read_b64_tr_b16 v[52:53], v4 offset:10752
  ds_read_b64_tr_b16 v[54:55], v4 offset:11648
  v_lshlrev_b32 v8, 16, v212
  v_and_b32 v9, 0xffff0000, v212
  v_fma_f32 v8, v8, v6, v7
  v_mfma_f32_32x32x16_bf16 v[112:127], v[28:31], v[12:15], v[112:127]
  ds_read_b64_tr_b16 v[56:57], v4 offset:10784
  ds_read_b64_tr_b16 v[58:59], v4 offset:11680
  v_fma_f32 v9, v9, v6, v7
  v_cvt_pk_bf16_f32 v16, v8, v9
  v_lshlrev_b32 v10, 16, v213
  v_mfma_f32_32x32x16_bf16 v[128:143], v[32:35], v[12:15], v[128:143]
  ds_read_b64_tr_b16 v[60:61], v4 offset:10816
  ds_read_b64_tr_b16 v[62:63], v4 offset:11712
  v_and_b32 v11, 0xffff0000, v213
  v_fma_f32 v10, v10, v6, v7
  v_fma_f32 v11, v11, v6, v7
  v_mfma_f32_32x32x16_bf16 v[144:159], v[36:39], v[12:15], v[144:159]
  ds_read_b64_tr_b16 v[64:65], v4 offset:10848
  ds_read_b64_tr_b16 v[66:67], v4 offset:11744
  ds_read_b128 v[208:211], v20
  v_cvt_pk_bf16_f32 v17, v10, v11
  v_lshlrev_b32 v8, 16, v214
  v_and_b32 v9, 0xffff0000, v214
  s_waitcnt lgkmcnt(11)
  v_mfma_f32_32x32x16_bf16 v[160:175], v[40:43], v[12:15], v[160:175]
  ds_read_b64_tr_b16 v[68:69], v4 offset:10880
  ds_read_b64_tr_b16 v[70:71], v4 offset:11776
  v_fma_f32 v8, v8, v6, v7
  v_fma_f32 v9, v9, v6, v7
  v_cvt_pk_bf16_f32 v18, v8, v9
  v_mfma_f32_32x32x16_bf16 v[176:191], v[44:47], v[12:15], v[176:191]
  ds_read_b64_tr_b16 v[72:73], v4 offset:10912
  ds_read_b64_tr_b16 v[74:75], v4 offset:11808
  v_lshlrev_b32 v10, 16, v215
  v_and_b32 v11, 0xffff0000, v215
  v_fma_f32 v10, v10, v6, v7
  s_waitcnt lgkmcnt(13)
  v_mfma_f32_32x32x16_bf16 v[192:207], v[48:51], v[12:15], v[192:207]
  ds_read_b64_tr_b16 v[76:77], v4 offset:10944
  ds_read_b64_tr_b16 v[78:79], v4 offset:11840
  v_fma_f32 v11, v11, v6, v7
  v_cvt_pk_bf16_f32 v19, v10, v11
  s_nop 0
  s_waitcnt lgkmcnt(11)
  v_mfma_f32_32x32x16_bf16 v[96:111], v[52:55], v[16:19], v[96:111]
  s_waitcnt lgkmcnt(6)
  v_lshlrev_b32 v8, 16, v208
  v_and_b32 v9, 0xffff0000, v208
  v_fma_f32 v8, v8, v6, v7
  v_mfma_f32_32x32x16_bf16 v[112:127], v[56:59], v[16:19], v[112:127]
  v_fma_f32 v9, v9, v6, v7
  v_cvt_pk_bf16_f32 v12, v8, v9
  v_lshlrev_b32 v10, 16, v209
  v_mfma_f32_32x32x16_bf16 v[128:143], v[60:63], v[16:19], v[128:143]
  s_waitcnt lgkmcnt(0)
  s_barrier
  ds_read_b64_tr_b16 v[24:25], v5 offset:0
  ds_read_b64_tr_b16 v[26:27], v5 offset:896
  ds_read_b64_tr_b16 v[28:29], v5 offset:32
  ds_read_b64_tr_b16 v[30:31], v5 offset:928
  v_and_b32 v11, 0xffff0000, v209
  v_fma_f32 v10, v10, v6, v7
  v_fma_f32 v11, v11, v6, v7
  v_mfma_f32_32x32x16_bf16 v[144:159], v[64:67], v[16:19], v[144:159]
  ds_read_b64_tr_b16 v[32:33], v5 offset:64
  ds_read_b64_tr_b16 v[34:35], v5 offset:960
  ds_read_b64_tr_b16 v[36:37], v5 offset:96
  ds_read_b64_tr_b16 v[38:39], v5 offset:992
  ds_read_b128 v[212:215], v21
  v_cvt_pk_bf16_f32 v13, v10, v11
  v_lshlrev_b32 v8, 16, v210
  v_and_b32 v9, 0xffff0000, v210
  v_mfma_f32_32x32x16_bf16 v[160:175], v[68:71], v[16:19], v[160:175]
  ds_read_b64_tr_b16 v[40:41], v5 offset:128
  ds_read_b64_tr_b16 v[42:43], v5 offset:1024
  ds_read_b64_tr_b16 v[44:45], v5 offset:160
  ds_read_b64_tr_b16 v[46:47], v5 offset:1056
  v_fma_f32 v8, v8, v6, v7
  v_fma_f32 v9, v9, v6, v7
  v_cvt_pk_bf16_f32 v14, v8, v9
  v_mfma_f32_32x32x16_bf16 v[176:191], v[72:75], v[16:19], v[176:191]
  ds_read_b64_tr_b16 v[48:49], v5 offset:192
  ds_read_b64_tr_b16 v[50:51], v5 offset:1088
  v_lshlrev_b32 v10, 16, v211
  v_and_b32 v11, 0xffff0000, v211
  v_fma_f32 v10, v10, v6, v7
  v_mfma_f32_32x32x16_bf16 v[192:207], v[76:79], v[16:19], v[192:207]
  v_fma_f32 v11, v11, v6, v7
  v_cvt_pk_bf16_f32 v15, v10, v11
  v_mov_b32 v4, v5
  s_add_u32 s40, s40, 1
  s_cmp_eq_u32 s40, 3
  s_cselect_b32 s40, 0, s40
  s_mov_b32 s3, 28800
  s_cmov_b32 s3, 0xffff1f00
  v_add_u32 v5, s3, v5
  v_mov_b32 v80, v20
  v_mov_b32 v81, v21
  v_xor_b32 v82, 64, v20
  v_xor_b32 v83, 96, v20
  v_add_u32 v20, 16384, v20
  v_and_b32 v20, 0xffff, v20
  v_xor_b32 v21, 32, v20
  s_add_u32 s42, s42, 1
  s_cmp_lt_u32 s42, 8
  s_cbranch_scc1 k3_kernel_loop
  s_waitcnt lgkmcnt(0)
  v_and_b32 v8, 31, v1
  v_mul_u32_u24 v80, 240, v8
  v_lshrrev_b32 v8, 5, v1
  v_lshl_add_u32 v80, v8, 4, v80
  s_mul_i32 s3, s28, 7680
  v_add_u32 v80, s3, v80
  v_lshrrev_b32 v8, 3, v1
  v_and_b32 v9, 7, v1
  v_mul_u32_u24 v81, 240, v8
  v_lshl_add_u32 v81, v9, 4, v81
  v_add_u32 v81, s3, v81
  s_lshl_b32 s3, s29, 7
  s_lshl_b32 s31, s28, 5
  s_add_u32 s3, s3, s31
  v_add_u32 v8, s3, v8
  v_mul_u32_u24 v82, 3584, v8
  v_lshl_add_u32 v82, v9, 4, v82
  s_mul_i32 s3, s30, 224
  v_add_u32 v82, s3, v82
  s_nop 7
  s_nop 7
  v_pk_mul_f32 v[24:25], v[96:97], v[96:97]
  v_pk_mul_f32 v[32:33], v[98:99], v[98:99]
  v_pk_fma_f32 v[26:27], v[24:25], v[84:85], v[86:87]
  v_pk_fma_f32 v[34:35], v[32:33], v[84:85], v[86:87]
  v_pk_mul_f32 v[26:27], v[26:27], v[96:97]
  v_pk_mul_f32 v[34:35], v[34:35], v[98:99]
  v_exp_f32 v26, v26
  v_exp_f32 v27, v27
  v_exp_f32 v34, v34
  v_exp_f32 v35, v35
  v_pk_mul_f32 v[24:25], v[96:97], v[104:105]
  v_pk_mul_f32 v[32:33], v[98:99], v[106:107]
  v_pk_add_f32 v[26:27], v[26:27], v[88:89]
  v_pk_add_f32 v[34:35], v[34:35], v[88:89]
  v_rcp_f32 v26, v26
  v_rcp_f32 v27, v27
  v_rcp_f32 v34, v34
  v_rcp_f32 v35, v35
  s_nop 0
  v_pk_mul_f32 v[24:25], v[24:25], v[26:27]
  v_pk_mul_f32 v[32:33], v[32:33], v[34:35]
  v_cvt_pk_bf16_f32 v56, v24, v25
  v_cvt_pk_bf16_f32 v57, v32, v33
  v_pk_mul_f32 v[24:25], v[100:101], v[100:101]
  v_pk_mul_f32 v[32:33], v[102:103], v[102:103]
  v_pk_fma_f32 v[26:27], v[24:25], v[84:85], v[86:87]
  v_pk_fma_f32 v[34:35], v[32:33], v[84:85], v[86:87]
  v_pk_mul_f32 v[26:27], v[26:27], v[100:101]
  v_pk_mul_f32 v[34:35], v[34:35], v[102:103]
  v_exp_f32 v26, v26
  v_exp_f32 v27, v27
  v_exp_f32 v34, v34
  v_exp_f32 v35, v35
  v_pk_mul_f32 v[24:25], v[100:101], v[108:109]
  v_pk_mul_f32 v[32:33], v[102:103], v[110:111]
  v_pk_add_f32 v[26:27], v[26:27], v[88:89]
  v_pk_add_f32 v[34:35], v[34:35], v[88:89]
  v_rcp_f32 v26, v26
  v_rcp_f32 v27, v27
  v_rcp_f32 v34, v34
  v_rcp_f32 v35, v35
  s_nop 0
  v_pk_mul_f32 v[24:25], v[24:25], v[26:27]
  v_pk_mul_f32 v[32:33], v[32:33], v[34:35]
  v_cvt_pk_bf16_f32 v58, v24, v25
  v_cvt_pk_bf16_f32 v59, v32, v33
  ds_write_b128 v80, v[56:59] offset:0
  v_pk_mul_f32 v[24:25], v[112:113], v[112:113]
  v_pk_mul_f32 v[32:33], v[114:115], v[114:115]
  v_pk_fma_f32 v[26:27], v[24:25], v[84:85], v[86:87]
  v_pk_fma_f32 v[34:35], v[32:33], v[84:85], v[86:87]
  v_pk_mul_f32 v[26:27], v[26:27], v[112:113]
  v_pk_mul_f32 v[34:35], v[34:35], v[114:115]
  v_exp_f32 v26, v26
  v_exp_f32 v27, v27
  v_exp_f32 v34, v34
  v_exp_f32 v35, v35
  v_pk_mul_f32 v[24:25], v[112:113], v[120:121]
  v_pk_mul_f32 v[32:33], v[114:115], v[122:123]
  v_pk_add_f32 v[26:27], v[26:27], v[88:89]
  v_pk_add_f32 v[34:35], v[34:35], v[88:89]
  v_rcp_f32 v26, v26
  v_rcp_f32 v27, v27
  v_rcp_f32 v34, v34
  v_rcp_f32 v35, v35
  s_nop 0
  v_pk_mul_f32 v[24:25], v[24:25], v[26:27]
  v_pk_mul_f32 v[32:33], v[32:33], v[34:35]
  v_cvt_pk_bf16_f32 v64, v24, v25
  v_cvt_pk_bf16_f32 v65, v32, v33
  v_pk_mul_f32 v[24:25], v[116:117], v[116:117]
  v_pk_mul_f32 v[32:33], v[118:119], v[118:119]
  v_pk_fma_f32 v[26:27], v[24:25], v[84:85], v[86:87]
  v_pk_fma_f32 v[34:35], v[32:33], v[84:85], v[86:87]
  v_pk_mul_f32 v[26:27], v[26:27], v[116:117]
  v_pk_mul_f32 v[34:35], v[34:35], v[118:119]
  v_exp_f32 v26, v26
  v_exp_f32 v27, v27
  v_exp_f32 v34, v34
  v_exp_f32 v35, v35
  v_pk_mul_f32 v[24:25], v[116:117], v[124:125]
  v_pk_mul_f32 v[32:33], v[118:119], v[126:127]
  v_pk_add_f32 v[26:27], v[26:27], v[88:89]
  v_pk_add_f32 v[34:35], v[34:35], v[88:89]
  v_rcp_f32 v26, v26
  v_rcp_f32 v27, v27
  v_rcp_f32 v34, v34
  v_rcp_f32 v35, v35
  s_nop 0
  v_pk_mul_f32 v[24:25], v[24:25], v[26:27]
  v_pk_mul_f32 v[32:33], v[32:33], v[34:35]
  v_cvt_pk_bf16_f32 v66, v24, v25
  v_cvt_pk_bf16_f32 v67, v32, v33
  ds_write_b128 v80, v[64:67] offset:32
  v_pk_mul_f32 v[24:25], v[128:129], v[128:129]
  v_pk_mul_f32 v[32:33], v[130:131], v[130:131]
  v_pk_fma_f32 v[26:27], v[24:25], v[84:85], v[86:87]
  v_pk_fma_f32 v[34:35], v[32:33], v[84:85], v[86:87]
  v_pk_mul_f32 v[26:27], v[26:27], v[128:129]
  v_pk_mul_f32 v[34:35], v[34:35], v[130:131]
  v_exp_f32 v26, v26
  v_exp_f32 v27, v27
  v_exp_f32 v34, v34
  v_exp_f32 v35, v35
  v_pk_mul_f32 v[24:25], v[128:129], v[136:137]
  v_pk_mul_f32 v[32:33], v[130:131], v[138:139]
  v_pk_add_f32 v[26:27], v[26:27], v[88:89]
  v_pk_add_f32 v[34:35], v[34:35], v[88:89]
  v_rcp_f32 v26, v26
  v_rcp_f32 v27, v27
  v_rcp_f32 v34, v34
  v_rcp_f32 v35, v35
  s_nop 0
  v_pk_mul_f32 v[24:25], v[24:25], v[26:27]
  v_pk_mul_f32 v[32:33], v[32:33], v[34:35]
  v_cvt_pk_bf16_f32 v56, v24, v25
  v_cvt_pk_bf16_f32 v57, v32, v33
  v_pk_mul_f32 v[24:25], v[132:133], v[132:133]
  v_pk_mul_f32 v[32:33], v[134:135], v[134:135]
  v_pk_fma_f32 v[26:27], v[24:25], v[84:85], v[86:87]
  v_pk_fma_f32 v[34:35], v[32:33], v[84:85], v[86:87]
  v_pk_mul_f32 v[26:27], v[26:27], v[132:133]
  v_pk_mul_f32 v[34:35], v[34:35], v[134:135]
  v_exp_f32 v26, v26
  v_exp_f32 v27, v27
  v_exp_f32 v34, v34
  v_exp_f32 v35, v35
  v_pk_mul_f32 v[24:25], v[132:133], v[140:141]
  v_pk_mul_f32 v[32:33], v[134:135], v[142:143]
  v_pk_add_f32 v[26:27], v[26:27], v[88:89]
  v_pk_add_f32 v[34:35], v[34:35], v[88:89]
  v_rcp_f32 v26, v26
  v_rcp_f32 v27, v27
  v_rcp_f32 v34, v34
  v_rcp_f32 v35, v35
  s_nop 0
  v_pk_mul_f32 v[24:25], v[24:25], v[26:27]
  v_pk_mul_f32 v[32:33], v[32:33], v[34:35]
  v_cvt_pk_bf16_f32 v58, v24, v25
  v_cvt_pk_bf16_f32 v59, v32, v33
  ds_write_b128 v80, v[56:59] offset:64
  v_pk_mul_f32 v[24:25], v[144:145], v[144:145]
  v_pk_mul_f32 v[32:33], v[146:147], v[146:147]
  v_pk_fma_f32 v[26:27], v[24:25], v[84:85], v[86:87]
  v_pk_fma_f32 v[34:35], v[32:33], v[84:85], v[86:87]
  v_pk_mul_f32 v[26:27], v[26:27], v[144:145]
  v_pk_mul_f32 v[34:35], v[34:35], v[146:147]
  v_exp_f32 v26, v26
  v_exp_f32 v27, v27
  v_exp_f32 v34, v34
  v_exp_f32 v35, v35
  v_pk_mul_f32 v[24:25], v[144:145], v[152:153]
  v_pk_mul_f32 v[32:33], v[146:147], v[154:155]
  v_pk_add_f32 v[26:27], v[26:27], v[88:89]
  v_pk_add_f32 v[34:35], v[34:35], v[88:89]
  v_rcp_f32 v26, v26
  v_rcp_f32 v27, v27
  v_rcp_f32 v34, v34
  v_rcp_f32 v35, v35
  s_nop 0
  v_pk_mul_f32 v[24:25], v[24:25], v[26:27]
  v_pk_mul_f32 v[32:33], v[32:33], v[34:35]
  v_cvt_pk_bf16_f32 v64, v24, v25
  v_cvt_pk_bf16_f32 v65, v32, v33
  v_pk_mul_f32 v[24:25], v[148:149], v[148:149]
  v_pk_mul_f32 v[32:33], v[150:151], v[150:151]
  v_pk_fma_f32 v[26:27], v[24:25], v[84:85], v[86:87]
  v_pk_fma_f32 v[34:35], v[32:33], v[84:85], v[86:87]
  v_pk_mul_f32 v[26:27], v[26:27], v[148:149]
  v_pk_mul_f32 v[34:35], v[34:35], v[150:151]
  v_exp_f32 v26, v26
  v_exp_f32 v27, v27
  v_exp_f32 v34, v34
  v_exp_f32 v35, v35
  v_pk_mul_f32 v[24:25], v[148:149], v[156:157]
  v_pk_mul_f32 v[32:33], v[150:151], v[158:159]
  v_pk_add_f32 v[26:27], v[26:27], v[88:89]
  v_pk_add_f32 v[34:35], v[34:35], v[88:89]
  v_rcp_f32 v26, v26
  v_rcp_f32 v27, v27
  v_rcp_f32 v34, v34
  v_rcp_f32 v35, v35
  s_nop 0
  v_pk_mul_f32 v[24:25], v[24:25], v[26:27]
  v_pk_mul_f32 v[32:33], v[32:33], v[34:35]
  v_cvt_pk_bf16_f32 v66, v24, v25
  v_cvt_pk_bf16_f32 v67, v32, v33
  ds_write_b128 v80, v[64:67] offset:96
  s_waitcnt lgkmcnt(0)
  ds_read_b128 v[96:99], v81 offset:0
  ds_read_b128 v[100:103], v81 offset:1920
  ds_read_b128 v[104:107], v81 offset:3840
  ds_read_b128 v[108:111], v81 offset:5760
  s_waitcnt lgkmcnt(3)
  s_mov_b32 s3, 0
  buffer_store_dwordx4 v[96:99], v82, s[16:19], s3 offen sc1
  s_waitcnt lgkmcnt(2)
  s_mov_b32 s3, 28672
  buffer_store_dwordx4 v[100:103], v82, s[16:19], s3 offen sc1
  s_waitcnt lgkmcnt(1)
  s_mov_b32 s3, 57344
  buffer_store_dwordx4 v[104:107], v82, s[16:19], s3 offen sc1
  s_waitcnt lgkmcnt(0)
  s_mov_b32 s3, 86016
  buffer_store_dwordx4 v[108:111], v82, s[16:19], s3 offen sc1
  v_pk_mul_f32 v[24:25], v[160:161], v[160:161]
  v_pk_mul_f32 v[32:33], v[162:163], v[162:163]
  v_pk_fma_f32 v[26:27], v[24:25], v[84:85], v[86:87]
  v_pk_fma_f32 v[34:35], v[32:33], v[84:85], v[86:87]
  v_pk_mul_f32 v[26:27], v[26:27], v[160:161]
  v_pk_mul_f32 v[34:35], v[34:35], v[162:163]
  v_exp_f32 v26, v26
  v_exp_f32 v27, v27
  v_exp_f32 v34, v34
  v_exp_f32 v35, v35
  v_pk_mul_f32 v[24:25], v[160:161], v[168:169]
  v_pk_mul_f32 v[32:33], v[162:163], v[170:171]
  v_pk_add_f32 v[26:27], v[26:27], v[88:89]
  v_pk_add_f32 v[34:35], v[34:35], v[88:89]
  v_rcp_f32 v26, v26
  v_rcp_f32 v27, v27
  v_rcp_f32 v34, v34
  v_rcp_f32 v35, v35
  s_nop 0
  v_pk_mul_f32 v[24:25], v[24:25], v[26:27]
  v_pk_mul_f32 v[32:33], v[32:33], v[34:35]
  v_cvt_pk_bf16_f32 v56, v24, v25
  v_cvt_pk_bf16_f32 v57, v32, v33
  v_pk_mul_f32 v[24:25], v[164:165], v[164:165]
  v_pk_mul_f32 v[32:33], v[166:167], v[166:167]
  v_pk_fma_f32 v[26:27], v[24:25], v[84:85], v[86:87]
  v_pk_fma_f32 v[34:35], v[32:33], v[84:85], v[86:87]
  v_pk_mul_f32 v[26:27], v[26:27], v[164:165]
  v_pk_mul_f32 v[34:35], v[34:35], v[166:167]
  v_exp_f32 v26, v26
  v_exp_f32 v27, v27
  v_exp_f32 v34, v34
  v_exp_f32 v35, v35
  v_pk_mul_f32 v[24:25], v[164:165], v[172:173]
  v_pk_mul_f32 v[32:33], v[166:167], v[174:175]
  v_pk_add_f32 v[26:27], v[26:27], v[88:89]
  v_pk_add_f32 v[34:35], v[34:35], v[88:89]
  v_rcp_f32 v26, v26
  v_rcp_f32 v27, v27
  v_rcp_f32 v34, v34
  v_rcp_f32 v35, v35
  s_nop 0
  v_pk_mul_f32 v[24:25], v[24:25], v[26:27]
  v_pk_mul_f32 v[32:33], v[32:33], v[34:35]
  v_cvt_pk_bf16_f32 v58, v24, v25
  v_cvt_pk_bf16_f32 v59, v32, v33
  ds_write_b128 v80, v[56:59] offset:128
  v_pk_mul_f32 v[24:25], v[176:177], v[176:177]
  v_pk_mul_f32 v[32:33], v[178:179], v[178:179]
  v_pk_fma_f32 v[26:27], v[24:25], v[84:85], v[86:87]
  v_pk_fma_f32 v[34:35], v[32:33], v[84:85], v[86:87]
  v_pk_mul_f32 v[26:27], v[26:27], v[176:177]
  v_pk_mul_f32 v[34:35], v[34:35], v[178:179]
  v_exp_f32 v26, v26
  v_exp_f32 v27, v27
  v_exp_f32 v34, v34
  v_exp_f32 v35, v35
  v_pk_mul_f32 v[24:25], v[176:177], v[184:185]
  v_pk_mul_f32 v[32:33], v[178:179], v[186:187]
  v_pk_add_f32 v[26:27], v[26:27], v[88:89]
  v_pk_add_f32 v[34:35], v[34:35], v[88:89]
  v_rcp_f32 v26, v26
  v_rcp_f32 v27, v27
  v_rcp_f32 v34, v34
  v_rcp_f32 v35, v35
  s_nop 0
  v_pk_mul_f32 v[24:25], v[24:25], v[26:27]
  v_pk_mul_f32 v[32:33], v[32:33], v[34:35]
  v_cvt_pk_bf16_f32 v64, v24, v25
  v_cvt_pk_bf16_f32 v65, v32, v33
  v_pk_mul_f32 v[24:25], v[180:181], v[180:181]
  v_pk_mul_f32 v[32:33], v[182:183], v[182:183]
  v_pk_fma_f32 v[26:27], v[24:25], v[84:85], v[86:87]
  v_pk_fma_f32 v[34:35], v[32:33], v[84:85], v[86:87]
  v_pk_mul_f32 v[26:27], v[26:27], v[180:181]
  v_pk_mul_f32 v[34:35], v[34:35], v[182:183]
  v_exp_f32 v26, v26
  v_exp_f32 v27, v27
  v_exp_f32 v34, v34
  v_exp_f32 v35, v35
  v_pk_mul_f32 v[24:25], v[180:181], v[188:189]
  v_pk_mul_f32 v[32:33], v[182:183], v[190:191]
  v_pk_add_f32 v[26:27], v[26:27], v[88:89]
  v_pk_add_f32 v[34:35], v[34:35], v[88:89]
  v_rcp_f32 v26, v26
  v_rcp_f32 v27, v27
  v_rcp_f32 v34, v34
  v_rcp_f32 v35, v35
  s_nop 0
  v_pk_mul_f32 v[24:25], v[24:25], v[26:27]
  v_pk_mul_f32 v[32:33], v[32:33], v[34:35]
  v_cvt_pk_bf16_f32 v66, v24, v25
  v_cvt_pk_bf16_f32 v67, v32, v33
  ds_write_b128 v80, v[64:67] offset:160
  v_pk_mul_f32 v[24:25], v[192:193], v[192:193]
  v_pk_mul_f32 v[32:33], v[194:195], v[194:195]
  v_pk_fma_f32 v[26:27], v[24:25], v[84:85], v[86:87]
  v_pk_fma_f32 v[34:35], v[32:33], v[84:85], v[86:87]
  v_pk_mul_f32 v[26:27], v[26:27], v[192:193]
  v_pk_mul_f32 v[34:35], v[34:35], v[194:195]
  v_exp_f32 v26, v26
  v_exp_f32 v27, v27
  v_exp_f32 v34, v34
  v_exp_f32 v35, v35
  v_pk_mul_f32 v[24:25], v[192:193], v[200:201]
  v_pk_mul_f32 v[32:33], v[194:195], v[202:203]
  v_pk_add_f32 v[26:27], v[26:27], v[88:89]
  v_pk_add_f32 v[34:35], v[34:35], v[88:89]
  v_rcp_f32 v26, v26
  v_rcp_f32 v27, v27
  v_rcp_f32 v34, v34
  v_rcp_f32 v35, v35
  s_nop 0
  v_pk_mul_f32 v[24:25], v[24:25], v[26:27]
  v_pk_mul_f32 v[32:33], v[32:33], v[34:35]
  v_cvt_pk_bf16_f32 v56, v24, v25
  v_cvt_pk_bf16_f32 v57, v32, v33
  v_pk_mul_f32 v[24:25], v[196:197], v[196:197]
  v_pk_mul_f32 v[32:33], v[198:199], v[198:199]
  v_pk_fma_f32 v[26:27], v[24:25], v[84:85], v[86:87]
  v_pk_fma_f32 v[34:35], v[32:33], v[84:85], v[86:87]
  v_pk_mul_f32 v[26:27], v[26:27], v[196:197]
  v_pk_mul_f32 v[34:35], v[34:35], v[198:199]
  v_exp_f32 v26, v26
  v_exp_f32 v27, v27
  v_exp_f32 v34, v34
  v_exp_f32 v35, v35
  v_pk_mul_f32 v[24:25], v[196:197], v[204:205]
  v_pk_mul_f32 v[32:33], v[198:199], v[206:207]
  v_pk_add_f32 v[26:27], v[26:27], v[88:89]
  v_pk_add_f32 v[34:35], v[34:35], v[88:89]
  v_rcp_f32 v26, v26
  v_rcp_f32 v27, v27
  v_rcp_f32 v34, v34
  v_rcp_f32 v35, v35
  s_nop 0
  v_pk_mul_f32 v[24:25], v[24:25], v[26:27]
  v_pk_mul_f32 v[32:33], v[32:33], v[34:35]
  v_cvt_pk_bf16_f32 v58, v24, v25
  v_cvt_pk_bf16_f32 v59, v32, v33
  ds_write_b128 v80, v[56:59] offset:192
  v_and_b32 v8, 7, v1
  v_cmp_gt_u32 vcc, 6, v8
  s_waitcnt lgkmcnt(0)
  s_and_saveexec_b64 s[40:41], vcc
  ds_read_b128 v[112:115], v81 offset:128
  ds_read_b128 v[116:119], v81 offset:2048
  ds_read_b128 v[120:123], v81 offset:3968
  ds_read_b128 v[124:127], v81 offset:5888
  s_waitcnt lgkmcnt(3)
  s_mov_b32 s3, 0
  buffer_store_dwordx4 v[112:115], v82, s[16:19], s3 offen offset:128 sc1
  s_waitcnt lgkmcnt(2)
  s_mov_b32 s3, 28672
  buffer_store_dwordx4 v[116:119], v82, s[16:19], s3 offen offset:128 sc1
  s_waitcnt lgkmcnt(1)
  s_mov_b32 s3, 57344
  buffer_store_dwordx4 v[120:123], v82, s[16:19], s3 offen offset:128 sc1
  s_waitcnt lgkmcnt(0)
  s_mov_b32 s3, 86016
  buffer_store_dwordx4 v[124:127], v82, s[16:19], s3 offen offset:128 sc1
  s_mov_b64 exec, s[40:41]
  s_waitcnt vmcnt(0)
  s_barrier
  s_branch k4_kernel
k3_kernel_loader:
  s_and_b32 s31, s28, 1
  s_mul_i32 s3, s31, 448
  s_mul_i32 s34, s30, 224
  v_add_u32 v2, s3, v1
  v_mul_u32_u24 v3, 4682, v2
  v_lshrrev_b32 v3, 16, v3
  v_mul_u32_u24 v11, 14, v3
  v_sub_u32 v2, v2, v11
  v_mul_u32_u24 v3, 3584, v3
  v_lshl_add_u32 v3, v2, 4, v3
  v_add_u32 v4, s34, v3
  v_add_u32 v2, s3, v1
  v_add_u32 v2, 64, v2
  v_mul_u32_u24 v3, 4682, v2
  v_lshrrev_b32 v3, 16, v3
  v_mul_u32_u24 v11, 14, v3
  v_sub_u32 v2, v2, v11
  v_mul_u32_u24 v3, 3584, v3
  v_lshl_add_u32 v3, v2, 4, v3
  v_add_u32 v5, s34, v3
  v_add_u32 v2, s3, v1
  v_add_u32 v2, 128, v2
  v_mul_u32_u24 v3, 4682, v2
  v_lshrrev_b32 v3, 16, v3
  v_mul_u32_u24 v11, 14, v3
  v_sub_u32 v2, v2, v11
  v_mul_u32_u24 v3, 3584, v3
  v_lshl_add_u32 v3, v2, 4, v3
  v_add_u32 v6, s34, v3
  v_add_u32 v2, s3, v1
  v_add_u32 v2, 192, v2
  v_mul_u32_u24 v3, 4682, v2
  v_lshrrev_b32 v3, 16, v3
  v_mul_u32_u24 v11, 14, v3
  v_sub_u32 v2, v2, v11
  v_mul_u32_u24 v3, 3584, v3
  v_lshl_add_u32 v3, v2, 4, v3
  v_add_u32 v7, s34, v3
  v_add_u32 v2, s3, v1
  v_add_u32 v2, 256, v2
  v_mul_u32_u24 v3, 4682, v2
  v_lshrrev_b32 v3, 16, v3
  v_mul_u32_u24 v11, 14, v3
  v_sub_u32 v2, v2, v11
  v_mul_u32_u24 v3, 3584, v3
  v_lshl_add_u32 v3, v2, 4, v3
  v_add_u32 v8, s34, v3
  v_add_u32 v2, s3, v1
  v_add_u32 v2, 320, v2
  v_mul_u32_u24 v3, 4682, v2
  v_lshrrev_b32 v3, 16, v3
  v_mul_u32_u24 v11, 14, v3
  v_sub_u32 v2, v2, v11
  v_mul_u32_u24 v3, 3584, v3
  v_lshl_add_u32 v3, v2, 4, v3
  v_add_u32 v9, s34, v3
  v_add_u32 v2, s3, v1
  v_add_u32 v2, 384, v2
  v_mul_u32_u24 v3, 4682, v2
  v_lshrrev_b32 v3, 16, v3
  v_mul_u32_u24 v11, 14, v3
  v_sub_u32 v2, v2, v11
  v_mul_u32_u24 v3, 3584, v3
  v_lshl_add_u32 v3, v2, 4, v3
  v_add_u32 v10, s34, v3
  s_sub_u32 s3, s28, 4
  s_lshl_b32 s36, s3, 12
  s_lshl_b32 s3, s3, 5
  s_lshl_b32 s34, s29, 7
  s_add_u32 s3, s3, s34
  v_lshrrev_b32 v2, 3, v1
  v_add_u32 v2, s3, v2
  v_lshlrev_b32 v2, 10, v2
  v_and_b32 v3, 7, v1
  v_lshrrev_b32 v11, 4, v1
  v_xor_b32 v3, v3, v11
  v_lshl_add_u32 v12, v3, 4, v2
  v_xor_b32 v3, 4, v3
  v_lshl_add_u32 v13, v3, 4, v2
  s_mov_b32 s40, s38
  s_waitcnt lgkmcnt(0)
  s_cmp_ge_u32 s28, 6
  s_cselect_b32 s6, s46, s44
  s_cselect_b32 s7, s47, s45
  s_cselect_b32 s35, 14464, 0
  s_add_u32 s35, s35, 65536
  s_mov_b32 s12, s6
  s_mov_b32 s13, s7
  s_mov_b32 s14, 0x1c0000
  s_mov_b32 s15, 0x00020000
  s_add_u32 s8, s4, 0x200000
  s_addc_u32 s9, s5, 0
  s_mov_b32 s10, 0x200000
  s_mov_b32 s11, 0x00020000
  s_mul_i32 s3, s31, 7168
  s_add_u32 s35, s35, s3
  s_mul_i32 s34, s38, 229376
  s_add_u32 s38, s38, 1
  s_and_b32 s38, s38, 7
  s_add_u32 m0, s35, 0
  s_nop 0
  buffer_load_dwordx4 v4, s[12:15], s34 offen lds
  s_add_u32 m0, s35, 1024
  s_nop 0
  buffer_load_dwordx4 v5, s[12:15], s34 offen lds
  s_add_u32 m0, s35, 2048
  s_nop 0
  buffer_load_dwordx4 v6, s[12:15], s34 offen lds
  s_add_u32 m0, s35, 3072
  s_nop 0
  buffer_load_dwordx4 v7, s[12:15], s34 offen lds
  s_add_u32 m0, s35, 4096
  s_nop 0
  buffer_load_dwordx4 v8, s[12:15], s34 offen lds
  s_add_u32 m0, s35, 5120
  s_nop 0
  buffer_load_dwordx4 v9, s[12:15], s34 offen lds
  s_add_u32 m0, s35, 6144
  s_nop 0
  buffer_load_dwordx4 v10, s[12:15], s34 offen lds
  s_mul_i32 s34, s38, 229376
  s_add_u32 s38, s38, 1
  s_and_b32 s38, s38, 7
  s_add_u32 m0, s35, 28800
  s_nop 0
  buffer_load_dwordx4 v4, s[12:15], s34 offen lds
  s_add_u32 m0, s35, 29824
  s_nop 0
  buffer_load_dwordx4 v5, s[12:15], s34 offen lds
  s_add_u32 m0, s35, 30848
  s_nop 0
  buffer_load_dwordx4 v6, s[12:15], s34 offen lds
  s_add_u32 m0, s35, 31872
  s_nop 0
  buffer_load_dwordx4 v7, s[12:15], s34 offen lds
  s_add_u32 m0, s35, 32896
  s_nop 0
  buffer_load_dwordx4 v8, s[12:15], s34 offen lds
  s_add_u32 m0, s35, 33920
  s_nop 0
  buffer_load_dwordx4 v9, s[12:15], s34 offen lds
  s_add_u32 m0, s35, 34944
  s_nop 0
  buffer_load_dwordx4 v10, s[12:15], s34 offen lds
  s_mul_i32 s34, s38, 229376
  s_add_u32 s38, s38, 1
  s_and_b32 s38, s38, 7
  s_add_u32 m0, s35, 57600
  s_nop 0
  buffer_load_dwordx4 v4, s[12:15], s34 offen lds
  s_add_u32 m0, s35, 58624
  s_nop 0
  buffer_load_dwordx4 v5, s[12:15], s34 offen lds
  s_add_u32 m0, s35, 59648
  s_nop 0
  buffer_load_dwordx4 v6, s[12:15], s34 offen lds
  s_add_u32 m0, s35, 60672
  s_nop 0
  buffer_load_dwordx4 v7, s[12:15], s34 offen lds
  s_add_u32 m0, s35, 61696
  s_nop 0
  buffer_load_dwordx4 v8, s[12:15], s34 offen lds
  s_add_u32 m0, s35, 62720
  s_nop 0
  buffer_load_dwordx4 v9, s[12:15], s34 offen lds
  s_add_u32 m0, s35, 63744
  s_nop 0
  buffer_load_dwordx4 v10, s[12:15], s34 offen lds
  s_cmp_lg_u32 s28, 5
  s_cbranch_scc1 k3_kernel_nopoll
  s_add_u32 s16, s4, 0xd08000
  s_addc_u32 s17, s5, 0
  s_mov_b32 s18, 0x8000
  s_mov_b32 s19, 0x00020000
  s_lshl_b32 s3, s29, 11
  v_and_b32 v3, 15, v1
  v_lshlrev_b32 v3, 7, v3
  v_add_u32 v3, s3, v3
  s_mov_b32 s37, 0
k3_kernel_poll:
  buffer_load_dwordx4 v[16:19], v3, s[16:19], 0 offen sc1
  s_waitcnt vmcnt(0)
  v_xor_b32 v18, v18, v16
  v_xor_b32 v19, v19, v17
  v_subrev_co_u32 v16, vcc, s54, v16
  v_mov_b32 v20, s55
  s_nop 0
  v_subb_co_u32 v17, vcc, v17, v20, vcc
  v_xor_b32 v18, 0x5bd1e995, v18
  v_xor_b32 v19, 0x9e3779b9, v19
  v_lshrrev_b32 v16, 20, v16
  v_or_b32 v16, v16, v17
  v_or3_b32 v16, v16, v18, v19
  v_cmp_eq_u32 vcc, 0, v16
  s_add_u32 s37, s37, 1
  s_cmp_eq_u64 vcc, exec
  s_cbranch_scc1 k3_kernel_nopoll
  s_cmp_lt_u32 s37, 0x10000
  s_cbranch_scc1 k3_kernel_poll
k3_kernel_nopoll:
  s_barrier
  s_lshl_b32 s39, s40, 7
  s_add_u32 s40, s40, 1
  s_and_b32 s40, s40, 7
  s_add_u32 m0, s36, 0
  s_add_u32 s37, s39, 0
  buffer_load_dwordx4 v12, s[8:11], s37 offen sc1 lds
  s_add_u32 m0, s36, 1024
  s_add_u32 s37, s39, 8192
  buffer_load_dwordx4 v13, s[8:11], s37 offen sc1 lds
  s_add_u32 m0, s36, 2048
  s_add_u32 s37, s39, 16384
  buffer_load_dwordx4 v12, s[8:11], s37 offen sc1 lds
  s_add_u32 m0, s36, 3072
  s_add_u32 s37, s39, 24576
  buffer_load_dwordx4 v13, s[8:11], s37 offen sc1 lds
  s_lshl_b32 s39, s40, 7
  s_add_u32 s40, s40, 1
  s_and_b32 s40, s40, 7
  s_add_u32 m0, s36, 16384
  s_add_u32 s37, s39, 0
  buffer_load_dwordx4 v12, s[8:11], s37 offen sc1 lds
  s_add_u32 m0, s36, 17408
  s_add_u32 s37, s39, 8192
  buffer_load_dwordx4 v13, s[8:11], s37 offen sc1 lds
  s_add_u32 m0, s36, 18432
  s_add_u32 s37, s39, 16384
  buffer_load_dwordx4 v12, s[8:11], s37 offen sc1 lds
  s_add_u32 m0, s36, 19456
  s_add_u32 s37, s39, 24576
  buffer_load_dwordx4 v13, s[8:11], s37 offen sc1 lds
  s_waitcnt vmcnt(0)
  s_barrier
  s_lshl_b32 s39, s40, 7
  s_add_u32 s40, s40, 1
  s_and_b32 s40, s40, 7
  s_add_u32 m0, s36, 32768
  s_add_u32 s37, s39, 0
  buffer_load_dwordx4 v12, s[8:11], s37 offen sc1 lds
  s_add_u32 m0, s36, 33792
  s_add_u32 s37, s39, 8192
  buffer_load_dwordx4 v13, s[8:11], s37 offen sc1 lds
  s_add_u32 m0, s36, 34816
  s_add_u32 s37, s39, 16384
  buffer_load_dwordx4 v12, s[8:11], s37 offen sc1 lds
  s_add_u32 m0, s36, 35840
  s_add_u32 s37, s39, 24576
  buffer_load_dwordx4 v13, s[8:11], s37 offen sc1 lds
  s_lshl_b32 s39, s40, 7
  s_add_u32 s40, s40, 1
  s_and_b32 s40, s40, 7
  s_add_u32 m0, s36, 49152
  s_add_u32 s37, s39, 0
  buffer_load_dwordx4 v12, s[8:11], s37 offen sc1 lds
  s_add_u32 m0, s36, 50176
  s_add_u32 s37, s39, 8192
  buffer_load_dwordx4 v13, s[8:11], s37 offen sc1 lds
  s_add_u32 m0, s36, 51200
  s_add_u32 s37, s39, 16384
  buffer_load_dwordx4 v12, s[8:11], s37 offen sc1 lds
  s_add_u32 m0, s36, 52224
  s_add_u32 s37, s39, 24576
  buffer_load_dwordx4 v13, s[8:11], s37 offen sc1 lds
  s_waitcnt vmcnt(4)
  s_barrier
  s_mul_i32 s34, s38, 229376
  s_add_u32 s38, s38, 1
  s_and_b32 s38, s38, 7
  s_add_u32 m0, s35, 0
  s_nop 0
  buffer_load_dwordx4 v4, s[12:15], s34 offen lds
  s_add_u32 m0, s35, 1024
  s_nop 0
  buffer_load_dwordx4 v5, s[12:15], s34 offen lds
  s_add_u32 m0, s35, 2048
  s_nop 0
  buffer_load_dwordx4 v6, s[12:15], s34 offen lds
  s_add_u32 m0, s35, 3072
  s_nop 0
  buffer_load_dwordx4 v7, s[12:15], s34 offen lds
  s_add_u32 m0, s35, 4096
  s_nop 0
  buffer_load_dwordx4 v8, s[12:15], s34 offen lds
  s_add_u32 m0, s35, 5120
  s_nop 0
  buffer_load_dwordx4 v9, s[12:15], s34 offen lds
  s_add_u32 m0, s35, 6144
  s_nop 0
  buffer_load_dwordx4 v10, s[12:15], s34 offen lds
  s_lshl_b32 s39, s40, 7
  s_add_u32 s40, s40, 1
  s_and_b32 s40, s40, 7
  s_add_u32 m0, s36, 0
  s_add_u32 s37, s39, 0
  buffer_load_dwordx4 v12, s[8:11], s37 offen sc1 lds
  s_add_u32 m0, s36, 1024
  s_add_u32 s37, s39, 8192
  buffer_load_dwordx4 v13, s[8:11], s37 offen sc1 lds
  s_add_u32 m0, s36, 2048
  s_add_u32 s37, s39, 16384
  buffer_load_dwordx4 v12, s[8:11], s37 offen sc1 lds
  s_add_u32 m0, s36, 3072
  s_add_u32 s37, s39, 24576
  buffer_load_dwordx4 v13, s[8:11], s37 offen sc1 lds
  s_waitcnt vmcnt(11)
  s_barrier
  s_mul_i32 s34, s38, 229376
  s_add_u32 s38, s38, 1
  s_and_b32 s38, s38, 7
  s_add_u32 m0, s35, 28800
  s_nop 0
  buffer_load_dwordx4 v4, s[12:15], s34 offen lds
  s_add_u32 m0, s35, 29824
  s_nop 0
  buffer_load_dwordx4 v5, s[12:15], s34 offen lds
  s_add_u32 m0, s35, 30848
  s_nop 0
  buffer_load_dwordx4 v6, s[12:15], s34 offen lds
  s_add_u32 m0, s35, 31872
  s_nop 0
  buffer_load_dwordx4 v7, s[12:15], s34 offen lds
  s_add_u32 m0, s35, 32896
  s_nop 0
  buffer_load_dwordx4 v8, s[12:15], s34 offen lds
  s_add_u32 m0, s35, 33920
  s_nop 0
  buffer_load_dwordx4 v9, s[12:15], s34 offen lds
  s_add_u32 m0, s35, 34944
  s_nop 0
  buffer_load_dwordx4 v10, s[12:15], s34 offen lds
  s_lshl_b32 s39, s40, 7
  s_add_u32 s40, s40, 1
  s_and_b32 s40, s40, 7
  s_add_u32 m0, s36, 16384
  s_add_u32 s37, s39, 0
  buffer_load_dwordx4 v12, s[8:11], s37 offen sc1 lds
  s_add_u32 m0, s36, 17408
  s_add_u32 s37, s39, 8192
  buffer_load_dwordx4 v13, s[8:11], s37 offen sc1 lds
  s_add_u32 m0, s36, 18432
  s_add_u32 s37, s39, 16384
  buffer_load_dwordx4 v12, s[8:11], s37 offen sc1 lds
  s_add_u32 m0, s36, 19456
  s_add_u32 s37, s39, 24576
  buffer_load_dwordx4 v13, s[8:11], s37 offen sc1 lds
  s_waitcnt vmcnt(11)
  s_barrier
  s_mul_i32 s34, s38, 229376
  s_add_u32 s38, s38, 1
  s_and_b32 s38, s38, 7
  s_add_u32 m0, s35, 57600
  s_nop 0
  buffer_load_dwordx4 v4, s[12:15], s34 offen lds
  s_add_u32 m0, s35, 58624
  s_nop 0
  buffer_load_dwordx4 v5, s[12:15], s34 offen lds
  s_add_u32 m0, s35, 59648
  s_nop 0
  buffer_load_dwordx4 v6, s[12:15], s34 offen lds
  s_add_u32 m0, s35, 60672
  s_nop 0
  buffer_load_dwordx4 v7, s[12:15], s34 offen lds
  s_add_u32 m0, s35, 61696
  s_nop 0
  buffer_load_dwordx4 v8, s[12:15], s34 offen lds
  s_add_u32 m0, s35, 62720
  s_nop 0
  buffer_load_dwordx4 v9, s[12:15], s34 offen lds
  s_add_u32 m0, s35, 63744
  s_nop 0
  buffer_load_dwordx4 v10, s[12:15], s34 offen lds
  s_lshl_b32 s39, s40, 7
  s_add_u32 s40, s40, 1
  s_and_b32 s40, s40, 7
  s_add_u32 m0, s36, 32768
  s_add_u32 s37, s39, 0
  buffer_load_dwordx4 v12, s[8:11], s37 offen sc1 lds
  s_add_u32 m0, s36, 33792
  s_add_u32 s37, s39, 8192
  buffer_load_dwordx4 v13, s[8:11], s37 offen sc1 lds
  s_add_u32 m0, s36, 34816
  s_add_u32 s37, s39, 16384
  buffer_load_dwordx4 v12, s[8:11], s37 offen sc1 lds
  s_add_u32 m0, s36, 35840
  s_add_u32 s37, s39, 24576
  buffer_load_dwordx4 v13, s[8:11], s37 offen sc1 lds
  s_waitcnt vmcnt(11)
  s_barrier
  s_mul_i32 s34, s38, 229376
  s_add_u32 s38, s38, 1
  s_and_b32 s38, s38, 7
  s_add_u32 m0, s35, 0
  s_nop 0
  buffer_load_dwordx4 v4, s[12:15], s34 offen lds
  s_add_u32 m0, s35, 1024
  s_nop 0
  buffer_load_dwordx4 v5, s[12:15], s34 offen lds
  s_add_u32 m0, s35, 2048
  s_nop 0
  buffer_load_dwordx4 v6, s[12:15], s34 offen lds
  s_add_u32 m0, s35, 3072
  s_nop 0
  buffer_load_dwordx4 v7, s[12:15], s34 offen lds
  s_add_u32 m0, s35, 4096
  s_nop 0
  buffer_load_dwordx4 v8, s[12:15], s34 offen lds
  s_add_u32 m0, s35, 5120
  s_nop 0
  buffer_load_dwordx4 v9, s[12:15], s34 offen lds
  s_add_u32 m0, s35, 6144
  s_nop 0
  buffer_load_dwordx4 v10, s[12:15], s34 offen lds
  s_lshl_b32 s39, s40, 7
  s_add_u32 s40, s40, 1
  s_and_b32 s40, s40, 7
  s_add_u32 m0, s36, 49152
  s_add_u32 s37, s39, 0
  buffer_load_dwordx4 v12, s[8:11], s37 offen sc1 lds
  s_add_u32 m0, s36, 50176
  s_add_u32 s37, s39, 8192
  buffer_load_dwordx4 v13, s[8:11], s37 offen sc1 lds
  s_add_u32 m0, s36, 51200
  s_add_u32 s37, s39, 16384
  buffer_load_dwordx4 v12, s[8:11], s37 offen sc1 lds
  s_add_u32 m0, s36, 52224
  s_add_u32 s37, s39, 24576
  buffer_load_dwordx4 v13, s[8:11], s37 offen sc1 lds
  s_waitcnt vmcnt(11)
  s_barrier
  s_mul_i32 s34, s38, 229376
  s_add_u32 s38, s38, 1
  s_and_b32 s38, s38, 7
  s_add_u32 m0, s35, 28800
  s_nop 0
  buffer_load_dwordx4 v4, s[12:15], s34 offen lds
  s_add_u32 m0, s35, 29824
  s_nop 0
  buffer_load_dwordx4 v5, s[12:15], s34 offen lds
  s_add_u32 m0, s35, 30848
  s_nop 0
  buffer_load_dwordx4 v6, s[12:15], s34 offen lds
  s_add_u32 m0, s35, 31872
  s_nop 0
  buffer_load_dwordx4 v7, s[12:15], s34 offen lds
  s_add_u32 m0, s35, 32896
  s_nop 0
  buffer_load_dwordx4 v8, s[12:15], s34 offen lds
  s_add_u32 m0, s35, 33920
  s_nop 0
  buffer_load_dwordx4 v9, s[12:15], s34 offen lds
  s_add_u32 m0, s35, 34944
  s_nop 0
  buffer_load_dwordx4 v10, s[12:15], s34 offen lds
  s_waitcnt vmcnt(7)
  s_barrier
  s_mov_b32 s16, s48
  s_mov_b32 s17, s49
  s_mov_b32 s18, 0x1c0000
  s_mov_b32 s19, 0x00020000
  s_lshr_b32 s3, s2, 3
  s_mul_i32 s3, s3, 56
  s_sub_u32 s34, s28, 4
  s_mul_i32 s34, s34, 14
  s_add_u32 s3, s3, s34
  s_lshl_b32 s3, s3, 10
  v_lshlrev_b32 v2, 7, v1
  buffer_load_dword v3, v2, s[16:19], s3 offen
  s_add_u32 s3, s3, 8192
  v_cmp_gt_u32 vcc, 48, v1
  s_and_saveexec_b64 s[40:41], vcc
  buffer_load_dword v3, v2, s[16:19], s3 offen
  s_mov_b64 exec, s[40:41]
  s_waitcnt vmcnt(2)
  s_barrier
  s_barrier
  s_barrier
  s_cmp_lg_u32 s28, 5
  s_cbranch_scc1 k4_kernel
  s_add_u32 s16, s4, 0xd10000
  s_addc_u32 s17, s5, 0
  s_mov_b32 s18, 0x8000
  s_mov_b32 s19, 0x00020000
  s_lshl_b32 s3, s29, 4
  s_add_u32 s3, s3, s30
  s_lshl_b32 s3, s3, 7
  v_mov_b32 v2, s3
  s_waitcnt lgkmcnt(0)
  v_mov_b32 v4, s56
  v_mov_b32 v5, s57
  v_xor_b32 v6, 0x5bd1e995, v4
  v_xor_b32 v7, 0x9e3779b9, v5
  v_cmp_eq_u32 vcc, 0, v1
  s_and_saveexec_b64 s[40:41], vcc
  buffer_store_dwordx4 v[4:7], v2, s[16:19], 0 offen sc1
  s_mov_b64 exec, s[40:41]
  s_branch k4_kernel
  s_waitcnt vmcnt(0)
k3_kernel_end:
  s_endpgm

k4_kernel:
  s_cmp_ge_u32 s2, 256
  s_cbranch_scc1 k4_kernel_end
  s_load_dwordx2 s[4:5], s[0:1], 72
  s_load_dwordx2 s[6:7], s[0:1], 48
  s_load_dwordx2 s[44:45], s[0:1], 56
  v_lshrrev_b32 v10, 6, v0
  v_and_b32 v1, 63, v0
  v_readfirstlane_b32 s28, v10
  s_and_b32 s3, s2, 7
  s_lshl_b32 s29, s3, 2
  s_lshr_b32 s3, s2, 6
  s_add_u32 s29, s29, s3
  s_lshr_b32 s31, s2, 3
  s_and_b32 s30, s31, 7
  s_lshl_b32 s42, s3, 1
  s_add_u32 s42, s42, s30
  s_cmp_ge_u32 s42, 7
  s_cselect_b32 s3, 7, 0
  s_sub_u32 s42, s42, s3
  s_mov_b32 s50, s42
  s_cmp_lt_u32 s28, 4
  s_cbranch_scc1 k4_kernel_main
  s_waitcnt lgkmcnt(0)
  s_cmp_lg_u32 s28, 5
  s_cbranch_scc1 k4_kernel_nopoll
  s_add_u32 s24, s4, 0xd10000
  s_addc_u32 s25, s5, 0
  s_mov_b32 s26, 0x8000
  s_mov_b32 s27, 0x00020000
  s_lshr_b32 s3, s29, 1
  s_lshl_b32 s3, s3, 11
  v_and_b32 v3, 15, v1
  v_lshlrev_b32 v3, 7, v3
  v_add_u32 v3, s3, v3
  s_mov_b32 s31, 0
k4_kernel_poll:
  buffer_load_dwordx4 v[16:19], v3, s[24:27], 0 offen sc1
  s_waitcnt vmcnt(0)
  v_xor_b32 v18, v18, v16
  v_xor_b32 v19, v19, v17
  v_subrev_co_u32 v16, vcc, s54, v16
  v_mov_b32 v20, s55
  s_nop 0
  v_subb_co_u32 v17, vcc, v17, v20, vcc
  v_xor_b32 v18, 0x5bd1e995, v18
  v_xor_b32 v19, 0x9e3779b9, v19
  v_lshrrev_b32 v16, 20, v16
  v_or_b32 v16, v16, v17
  v_or3_b32 v16, v16, v18, v19
  v_cmp_eq_u32 vcc, 0, v16
  s_add_u32 s31, s31, 1
  s_cmp_eq_u64 vcc, exec
  s_cbranch_scc1 k4_kernel_nopoll
  s_cmp_lt_u32 s31, 0x10000
  s_cbranch_scc1 k4_kernel_poll
k4_kernel_nopoll:
  s_barrier
  s_barrier
  s_endpgm
k4_kernel_main:
  s_mul_i32 s32, s28, 40960
  s_add_u32 s31, s28, 0
  s_and_b32 s31, s31, 3
  s_mul_i32 s36, s31, 57344
  s_add_u32 s31, s28, 1
  s_and_b32 s31, s31, 3
  s_mul_i32 s37, s31, 57344
  s_add_u32 s31, s28, 2
  s_and_b32 s31, s31, 3
  s_mul_i32 s38, s31, 57344
  s_add_u32 s31, s28, 3
  s_and_b32 s31, s31, 3
  s_mul_i32 s39, s31, 57344
  s_lshl_b32 s31, s29, 6
  v_lshrrev_b32 v10, 3, v1
  v_add_u32 v11, s31, v10
  s_mov_b32 s3, 3584
  v_mul_lo_u32 v2, v11, s3
  s_mul_i32 s3, s28, 896
  v_add_u32 v2, s3, v2
  v_and_b32 v10, 7, v1
  v_lshrrev_b32 v12, 4, v1
  v_xor_b32 v10, v10, v12
  v_xor_b32 v11, 4, v10
  v_add_u32 v15, 28672, v2
  v_lshl_add_u32 v15, v11, 4, v15
  v_lshl_add_u32 v2, v10, 4, v2
  v_and_b32 v11, 15, v1
  v_lshrrev_b32 v10, 1, v11
  v_xor_b32 v10, v10, v12
  v_lshlrev_b32 v13, 7, v11
  v_add_u32 v13, s32, v13
  v_lshl_add_u32 v13, v10, 4, v13
  v_xor_b32 v14, 64, v13
  s_lshl_b32 s3, s28, 4
  s_add_u32 s3, s3, s31
  v_add_u32 v11, s3, v11
  v_lshlrev_b32 v9, 10, v11
  v_lshl_add_u32 v9, v12, 3, v9
  s_lshl_b32 s3, s30, 7
  v_add_u32 v9, s3, v9
  v_lshrrev_b32 v10, 3, v1
  s_lshl_b32 s41, s28, 4
  s_add_u32 s41, s41, s31
  v_add_u32 v156, s41, v10
  v_lshlrev_b32 v156, 10, v156
  v_and_b32 v11, 7, v1
  v_lshl_add_u32 v156, v11, 4, v156
  v_add_u32 v156, s3, v156
  v_add_u32 v157, 8192, v156
  v_lshrrev_b32 v10, 3, v1
  v_lshlrev_b32 v3, 10, v10
  v_and_b32 v10, 1, v1
  v_lshl_add_u32 v3, v10, 4, v3
  s_mul_i32 s31, s28, 458752
  s_add_u32 s3, s3, s31
  v_add_u32 v3, s3, v3
  v_bfe_u32 v10, v1, 1, 2
  v_bfe_u32 v11, v1, 4, 1
  v_xor_b32 v10, v10, v11
  v_xor_b32 v11, 2, v10
  v_lshl_add_u32 v4, v11, 5, v3
  v_lshl_add_u32 v3, v10, 5, v3
  v_lshrrev_b32 v10, 4, v1
  v_bfe_u32 v11, v1, 2, 2
  v_lshl_add_u32 v12, v10, 3, v11
  v_lshlrev_b32 v12, 7, v12
  v_add_u32 v12, s32, v12
  v_and_b32 v5, 3, v1
  v_lshl_add_u32 v12, v5, 3, v12
  v_bfe_u32 v11, v1, 3, 1
  v_bfe_u32 v10, v1, 4, 1
  v_lshl_or_b32 v10, v10, 1, v11
  v_xor_b32 v11, 0, v10
  v_lshl_add_u32 v5, v11, 5, v12
  v_xor_b32 v11, 1, v10
  v_lshl_add_u32 v6, v11, 5, v12
  v_xor_b32 v11, 2, v10
  v_lshl_add_u32 v7, v11, 5, v12
  v_xor_b32 v11, 3, v10
  v_lshl_add_u32 v8, v11, 5, v12
  s_waitcnt lgkmcnt(0)
  s_add_u32 s8, s4, 0x400000
  s_addc_u32 s9, s5, 0
  s_mov_b32 s10, 0x700000
  s_mov_b32 s11, 0x00020000
  s_add_u32 s16, s4, 0x200000
  s_addc_u32 s17, s5, 0
  s_mov_b32 s18, 0x200000
  s_mov_b32 s19, 0x00020000
  s_mov_b32 s20, s44
  s_mov_b32 s21, s45
  s_mov_b32 s22, 0x200000
  s_mov_b32 s23, 0x00020000
  s_mov_b32 s12, s6
  s_mov_b32 s13, s7
  s_mov_b32 s14, 0x1c0000
  s_mov_b32 s15, 0x00020000
  s_lshl_b32 s40, s50, 16
  s_add_u32 s50, s50, 1
  s_cmp_ge_u32 s50, 7
  s_cselect_b32 s50, 0, s50
  s_add_u32 m0, s32, 24576
  s_nop 0
  buffer_load_dwordx4 v3, s[12:15], s40 offen lds
  s_add_u32 s40, s40, 8192
  s_add_u32 m0, s32, 25600
  s_nop 0
  buffer_load_dwordx4 v4, s[12:15], s40 offen lds
  s_add_u32 s40, s40, 8192
  s_add_u32 m0, s32, 26624
  s_nop 0
  buffer_load_dwordx4 v3, s[12:15], s40 offen lds
  s_add_u32 s40, s40, 8192
  s_add_u32 m0, s32, 27648
  s_nop 0
  buffer_load_dwordx4 v4, s[12:15], s40 offen lds
  s_add_u32 s40, s40, 8192
  s_add_u32 m0, s32, 28672
  s_nop 0
  buffer_load_dwordx4 v3, s[12:15], s40 offen lds
  s_add_u32 s40, s40, 8192
  s_add_u32 m0, s32, 29696
  s_nop 0
  buffer_load_dwordx4 v4, s[12:15], s40 offen lds
  s_add_u32 s40, s40, 8192
  s_add_u32 m0, s32, 30720
  s_nop 0
  buffer_load_dwordx4 v3, s[12:15], s40 offen lds
  s_add_u32 s40, s40, 8192
  s_add_u32 m0, s32, 31744
  s_nop 0
  buffer_load_dwordx4 v4, s[12:15], s40 offen lds
  s_add_u32 s40, s40, 8192
  s_lshl_b32 s40, s50, 16
  s_add_u32 s50, s50, 1
  s_cmp_ge_u32 s50, 7
  s_cselect_b32 s50, 0, s50
  s_add_u32 m0, s32, 32768
  s_nop 0
  buffer_load_dwordx4 v3, s[12:15], s40 offen lds
  s_add_u32 s40, s40, 8192
  s_add_u32 m0, s32, 33792
  s_nop 0
  buffer_load_dwordx4 v4, s[12:15], s40 offen lds
  s_add_u32 s40, s40, 8192
  s_add_u32 m0, s32, 34816
  s_nop 0
  buffer_load_dwordx4 v3, s[12:15], s40 offen lds
  s_add_u32 s40, s40, 8192
  s_add_u32 m0, s32, 35840
  s_nop 0
  buffer_load_dwordx4 v4, s[12:15], s40 offen lds
  s_add_u32 s40, s40, 8192
  s_barrier
  s_lshl_b32 s43, s42, 7
  s_add_u32 s42, s42, 1
  s_cmp_ge_u32 s42, 7
  s_cselect_b32 s42, 0, s42
  s_add_u32 s41, s36, s43
  s_add_u32 m0, s32, 0
  s_nop 0
  buffer_load_dwordx4 v2, s[8:11], s41 offen sc1 lds
  s_add_u32 m0, s32, 1024
  s_nop 0
  buffer_load_dwordx4 v15, s[8:11], s41 offen sc1 lds
  s_add_u32 s41, s37, s43
  s_add_u32 m0, s32, 2048
  s_nop 0
  buffer_load_dwordx4 v2, s[8:11], s41 offen sc1 lds
  s_add_u32 m0, s32, 3072
  s_nop 0
  buffer_load_dwordx4 v15, s[8:11], s41 offen sc1 lds
  s_add_u32 s41, s38, s43
  s_add_u32 m0, s32, 4096
  s_nop 0
  buffer_load_dwordx4 v2, s[8:11], s41 offen sc1 lds
  s_add_u32 m0, s32, 5120
  s_nop 0
  buffer_load_dwordx4 v15, s[8:11], s41 offen sc1 lds
  s_add_u32 s41, s39, s43
  s_add_u32 m0, s32, 6144
  s_nop 0
  buffer_load_dwordx4 v2, s[8:11], s41 offen sc1 lds
  s_add_u32 m0, s32, 7168
  s_nop 0
  buffer_load_dwordx4 v15, s[8:11], s41 offen sc1 lds
  s_lshl_b32 s43, s42, 7
  s_add_u32 s42, s42, 1
  s_cmp_ge_u32 s42, 7
  s_cselect_b32 s42, 0, s42
  s_add_u32 s41, s36, s43
  s_add_u32 m0, s32, 8192
  s_nop 0
  buffer_load_dwordx4 v2, s[8:11], s41 offen sc1 lds
  s_add_u32 m0, s32, 9216
  s_nop 0
  buffer_load_dwordx4 v15, s[8:11], s41 offen sc1 lds
  s_add_u32 s41, s37, s43
  s_add_u32 m0, s32, 10240
  s_nop 0
  buffer_load_dwordx4 v2, s[8:11], s41 offen sc1 lds
  s_add_u32 m0, s32, 11264
  s_nop 0
  buffer_load_dwordx4 v15, s[8:11], s41 offen sc1 lds
  s_add_u32 s41, s38, s43
  s_add_u32 m0, s32, 12288
  s_nop 0
  buffer_load_dwordx4 v2, s[8:11], s41 offen sc1 lds
  s_add_u32 m0, s32, 13312
  s_nop 0
  buffer_load_dwordx4 v15, s[8:11], s41 offen sc1 lds
  s_add_u32 s41, s39, s43
  s_add_u32 m0, s32, 14336
  s_nop 0
  buffer_load_dwordx4 v2, s[8:11], s41 offen sc1 lds
  s_add_u32 m0, s32, 15360
  s_nop 0
  buffer_load_dwordx4 v15, s[8:11], s41 offen sc1 lds
  s_waitcnt vmcnt(8)
  ds_read_b64_tr_b16 v[88:89], v5 offset:24576
  ds_read_b64_tr_b16 v[90:91], v5 offset:25088
  ds_read_b128 v[120:123], v13 offset:0
  ds_read_b64_tr_b16 v[92:93], v6 offset:24576
  ds_read_b64_tr_b16 v[94:95], v6 offset:25088
  ds_read_b128 v[124:127], v13 offset:2048
  ds_read_b64_tr_b16 v[96:97], v7 offset:24576
  ds_read_b64_tr_b16 v[98:99], v7 offset:25088
  ds_read_b128 v[128:131], v13 offset:4096
  ds_read_b64_tr_b16 v[100:101], v8 offset:24576
  ds_read_b64_tr_b16 v[102:103], v8 offset:25088
  ds_read_b128 v[132:135], v13 offset:6144
  s_waitcnt lgkmcnt(0)
  s_add_u32 m0, s32, 36864
  s_nop 0
  buffer_load_dwordx4 v3, s[12:15], s40 offen lds
  s_add_u32 s40, s40, 8192
  s_add_u32 m0, s32, 37888
  s_nop 0
  buffer_load_dwordx4 v4, s[12:15], s40 offen lds
  s_add_u32 s40, s40, 8192
  s_add_u32 m0, s32, 38912
  s_nop 0
  buffer_load_dwordx4 v3, s[12:15], s40 offen lds
  s_add_u32 s40, s40, 8192
  s_add_u32 m0, s32, 39936
  s_nop 0
  buffer_load_dwordx4 v4, s[12:15], s40 offen lds
  s_add_u32 s40, s40, 8192
  s_lshl_b32 s43, s42, 7
  s_add_u32 s42, s42, 1
  s_cmp_ge_u32 s42, 7
  s_cselect_b32 s42, 0, s42
  s_add_u32 s41, s36, s43
  s_add_u32 m0, s32, 16384
  s_nop 0
  buffer_load_dwordx4 v2, s[8:11], s41 offen sc1 lds
  s_add_u32 m0, s32, 17408
  s_nop 0
  buffer_load_dwordx4 v15, s[8:11], s41 offen sc1 lds
  s_add_u32 s41, s37, s43
  s_add_u32 m0, s32, 18432
  s_nop 0
  buffer_load_dwordx4 v2, s[8:11], s41 offen sc1 lds
  s_add_u32 m0, s32, 19456
  s_nop 0
  buffer_load_dwordx4 v15, s[8:11], s41 offen sc1 lds
  s_add_u32 s41, s38, s43
  s_add_u32 m0, s32, 20480
  s_nop 0
  buffer_load_dwordx4 v2, s[8:11], s41 offen sc1 lds
  s_add_u32 m0, s32, 21504
  s_nop 0
  buffer_load_dwordx4 v15, s[8:11], s41 offen sc1 lds
  s_add_u32 s41, s39, s43
  s_add_u32 m0, s32, 22528
  s_nop 0
  buffer_load_dwordx4 v2, s[8:11], s41 offen sc1 lds
  s_add_u32 m0, s32, 23552
  s_nop 0
  buffer_load_dwordx4 v15, s[8:11], s41 offen sc1 lds
  v_mfma_f32_16x16x32_bf16 v[24:27], v[88:91], v[120:123], 0
  ds_read_b64_tr_b16 v[104:105], v5 offset:28672
  v_mfma_f32_16x16x32_bf16 v[40:43], v[92:95], v[120:123], 0
  ds_read_b64_tr_b16 v[106:107], v5 offset:29184
  v_mfma_f32_16x16x32_bf16 v[56:59], v[96:99], v[120:123], 0
  ds_read_b128 v[136:139], v14 offset:0
  v_mfma_f32_16x16x32_bf16 v[72:75], v[100:103], v[120:123], 0
  ds_read_b64_tr_b16 v[108:109], v6 offset:28672
  v_mfma_f32_16x16x32_bf16 v[28:31], v[88:91], v[124:127], 0
  ds_read_b64_tr_b16 v[110:111], v6 offset:29184
  v_mfma_f32_16x16x32_bf16 v[44:47], v[92:95], v[124:127], 0
  ds_read_b128 v[140:143], v14 offset:2048
  v_mfma_f32_16x16x32_bf16 v[60:63], v[96:99], v[124:127], 0
  ds_read_b64_tr_b16 v[112:113], v7 offset:28672
  v_mfma_f32_16x16x32_bf16 v[76:79], v[100:103], v[124:127], 0
  ds_read_b64_tr_b16 v[114:115], v7 offset:29184
  v_mfma_f32_16x16x32_bf16 v[32:35], v[88:91], v[128:131], 0
  ds_read_b128 v[144:147], v14 offset:4096
  v_mfma_f32_16x16x32_bf16 v[48:51], v[92:95], v[128:131], 0
  ds_read_b64_tr_b16 v[116:117], v8 offset:28672
  v_mfma_f32_16x16x32_bf16 v[64:67], v[96:99], v[128:131], 0
  ds_read_b64_tr_b16 v[118:119], v8 offset:29184
  v_mfma_f32_16x16x32_bf16 v[80:83], v[100:103], v[128:131], 0
  ds_read_b128 v[148:151], v14 offset:6144
  v_mfma_f32_16x16x32_bf16 v[36:39], v[88:91], v[132:135], 0
  v_mfma_f32_16x16x32_bf16 v[52:55], v[92:95], v[132:135], 0
  v_mfma_f32_16x16x32_bf16 v[68:71], v[96:99], v[132:135], 0
  v_mfma_f32_16x16x32_bf16 v[84:87], v[100:103], v[132:135], 0
  s_waitcnt lgkmcnt(0)
  s_lshl_b32 s40, s50, 16
  s_add_u32 s50, s50, 1
  s_cmp_ge_u32 s50, 7
  s_cselect_b32 s50, 0, s50
  s_add_u32 m0, s32, 24576
  s_nop 0
  buffer_load_dwordx4 v3, s[12:15], s40 offen lds
  s_add_u32 s40, s40, 8192
  s_add_u32 m0, s32, 25600
  s_nop 0
  buffer_load_dwordx4 v4, s[12:15], s40 offen lds
  s_add_u32 s40, s40, 8192
  s_add_u32 m0, s32, 26624
  s_nop 0
  buffer_load_dwordx4 v3, s[12:15], s40 offen lds
  s_add_u32 s40, s40, 8192
  s_add_u32 m0, s32, 27648
  s_nop 0
  buffer_load_dwordx4 v4, s[12:15], s40 offen lds
  s_add_u32 s40, s40, 8192
  s_waitcnt vmcnt(16)
  v_mfma_f32_16x16x32_bf16 v[24:27], v[104:107], v[136:139], v[24:27]
  ds_read_b64_tr_b16 v[88:89], v5 offset:32768
  v_mfma_f32_16x16x32_bf16 v[40:43], v[108:111], v[136:139], v[40:43]
  ds_read_b64_tr_b16 v[90:91], v5 offset:33280
  v_mfma_f32_16x16x32_bf16 v[56:59], v[112:115], v[136:139], v[56:59]
  ds_read_b128 v[120:123], v13 offset:8192
  v_mfma_f32_16x16x32_bf16 v[72:75], v[116:119], v[136:139], v[72:75]
  ds_read_b64_tr_b16 v[92:93], v6 offset:32768
  v_mfma_f32_16x16x32_bf16 v[28:31], v[104:107], v[140:143], v[28:31]
  ds_read_b64_tr_b16 v[94:95], v6 offset:33280
  v_mfma_f32_16x16x32_bf16 v[44:47], v[108:111], v[140:143], v[44:47]
  ds_read_b128 v[124:127], v13 offset:10240
  v_mfma_f32_16x16x32_bf16 v[60:63], v[112:115], v[140:143], v[60:63]
  ds_read_b64_tr_b16 v[96:97], v7 offset:32768
  v_mfma_f32_16x16x32_bf16 v[76:79], v[116:119], v[140:143], v[76:79]
  ds_read_b64_tr_b16 v[98:99], v7 offset:33280
  v_mfma_f32_16x16x32_bf16 v[32:35], v[104:107], v[144:147], v[32:35]
  ds_read_b128 v[128:131], v13 offset:12288
  v_mfma_f32_16x16x32_bf16 v[48:51], v[108:111], v[144:147], v[48:51]
  ds_read_b64_tr_b16 v[100:101], v8 offset:32768
  v_mfma_f32_16x16x32_bf16 v[64:67], v[112:115], v[144:147], v[64:67]
  ds_read_b64_tr_b16 v[102:103], v8 offset:33280
  v_mfma_f32_16x16x32_bf16 v[80:83], v[116:119], v[144:147], v[80:83]
  ds_read_b128 v[132:135], v13 offset:14336
  v_mfma_f32_16x16x32_bf16 v[36:39], v[104:107], v[148:151], v[36:39]
  v_mfma_f32_16x16x32_bf16 v[52:55], v[108:111], v[148:151], v[52:55]
  v_mfma_f32_16x16x32_bf16 v[68:71], v[112:115], v[148:151], v[68:71]
  v_mfma_f32_16x16x32_bf16 v[84:87], v[116:119], v[148:151], v[84:87]
  s_waitcnt lgkmcnt(0)
  s_add_u32 m0, s32, 28672
  s_nop 0
  buffer_load_dwordx4 v3, s[12:15], s40 offen lds
  s_add_u32 s40, s40, 8192
  s_add_u32 m0, s32, 29696
  s_nop 0
  buffer_load_dwordx4 v4, s[12:15], s40 offen lds
  s_add_u32 s40, s40, 8192
  s_add_u32 m0, s32, 30720
  s_nop 0
  buffer_load_dwordx4 v3, s[12:15], s40 offen lds
  s_add_u32 s40, s40, 8192
  s_add_u32 m0, s32, 31744
  s_nop 0
  buffer_load_dwordx4 v4, s[12:15], s40 offen lds
  s_add_u32 s40, s40, 8192
  s_lshl_b32 s43, s42, 7
  s_add_u32 s42, s42, 1
  s_cmp_ge_u32 s42, 7
  s_cselect_b32 s42, 0, s42
  s_add_u32 s41, s36, s43
  s_add_u32 m0, s32, 0
  s_nop 0
  buffer_load_dwordx4 v2, s[8:11], s41 offen sc1 lds
  s_add_u32 m0, s32, 1024
  s_nop 0
  buffer_load_dwordx4 v15, s[8:11], s41 offen sc1 lds
  s_add_u32 s41, s37, s43
  s_add_u32 m0, s32, 2048
  s_nop 0
  buffer_load_dwordx4 v2, s[8:11], s41 offen sc1 lds
  s_add_u32 m0, s32, 3072
  s_nop 0
  buffer_load_dwordx4 v15, s[8:11], s41 offen sc1 lds
  s_add_u32 s41, s38, s43
  s_add_u32 m0, s32, 4096
  s_nop 0
  buffer_load_dwordx4 v2, s[8:11], s41 offen sc1 lds
  s_add_u32 m0, s32, 5120
  s_nop 0
  buffer_load_dwordx4 v15, s[8:11], s41 offen sc1 lds
  s_add_u32 s41, s39, s43
  s_add_u32 m0, s32, 6144
  s_nop 0
  buffer_load_dwordx4 v2, s[8:11], s41 offen sc1 lds
  s_add_u32 m0, s32, 7168
  s_nop 0
  buffer_load_dwordx4 v15, s[8:11], s41 offen sc1 lds
  s_waitcnt vmcnt(24)
  v_mfma_f32_16x16x32_bf16 v[24:27], v[88:91], v[120:123], v[24:27]
  ds_read_b64_tr_b16 v[104:105], v5 offset:36864
  v_mfma_f32_16x16x32_bf16 v[40:43], v[92:95], v[120:123], v[40:43]
  ds_read_b64_tr_b16 v[106:107], v5 offset:37376
  v_mfma_f32_16x16x32_bf16 v[56:59], v[96:99], v[120:123], v[56:59]
  ds_read_b128 v[136:139], v14 offset:8192
  v_mfma_f32_16x16x32_bf16 v[72:75], v[100:103], v[120:123], v[72:75]
  ds_read_b64_tr_b16 v[108:109], v6 offset:36864
  v_mfma_f32_16x16x32_bf16 v[28:31], v[88:91], v[124:127], v[28:31]
  ds_read_b64_tr_b16 v[110:111], v6 offset:37376
  v_mfma_f32_16x16x32_bf16 v[44:47], v[92:95], v[124:127], v[44:47]
  ds_read_b128 v[140:143], v14 offset:10240
  v_mfma_f32_16x16x32_bf16 v[60:63], v[96:99], v[124:127], v[60:63]
  ds_read_b64_tr_b16 v[112:113], v7 offset:36864
  v_mfma_f32_16x16x32_bf16 v[76:79], v[100:103], v[124:127], v[76:79]
  ds_read_b64_tr_b16 v[114:115], v7 offset:37376
  v_mfma_f32_16x16x32_bf16 v[32:35], v[88:91], v[128:131], v[32:35]
  ds_read_b128 v[144:147], v14 offset:12288
  v_mfma_f32_16x16x32_bf16 v[48:51], v[92:95], v[128:131], v[48:51]
  ds_read_b64_tr_b16 v[116:117], v8 offset:36864
  v_mfma_f32_16x16x32_bf16 v[64:67], v[96:99], v[128:131], v[64:67]
  ds_read_b64_tr_b16 v[118:119], v8 offset:37376
  v_mfma_f32_16x16x32_bf16 v[80:83], v[100:103], v[128:131], v[80:83]
  ds_read_b128 v[148:151], v14 offset:14336
  v_mfma_f32_16x16x32_bf16 v[36:39], v[88:91], v[132:135], v[36:39]
  v_mfma_f32_16x16x32_bf16 v[52:55], v[92:95], v[132:135], v[52:55]
  v_mfma_f32_16x16x32_bf16 v[68:71], v[96:99], v[132:135], v[68:71]
  v_mfma_f32_16x16x32_bf16 v[84:87], v[100:103], v[132:135], v[84:87]
  s_waitcnt lgkmcnt(0)
  s_lshl_b32 s40, s50, 16
  s_add_u32 s50, s50, 1
  s_cmp_ge_u32 s50, 7
  s_cselect_b32 s50, 0, s50
  s_add_u32 m0, s32, 32768
  s_nop 0
  buffer_load_dwordx4 v3, s[12:15], s40 offen lds
  s_add_u32 s40, s40, 8192
  s_add_u32 m0, s32, 33792
  s_nop 0
  buffer_load_dwordx4 v4, s[12:15], s40 offen lds
  s_add_u32 s40, s40, 8192
  s_add_u32 m0, s32, 34816
  s_nop 0
  buffer_load_dwordx4 v3, s[12:15], s40 offen lds
  s_add_u32 s40, s40, 8192
  s_add_u32 m0, s32, 35840
  s_nop 0
  buffer_load_dwordx4 v4, s[12:15], s40 offen lds
  s_add_u32 s40, s40, 8192
  s_waitcnt vmcnt(20)
  s_waitcnt vmcnt(16)
  v_mfma_f32_16x16x32_bf16 v[24:27], v[104:107], v[136:139], v[24:27]
  ds_read_b64_tr_b16 v[88:89], v5 offset:24576
  v_mfma_f32_16x16x32_bf16 v[40:43], v[108:111], v[136:139], v[40:43]
  ds_read_b64_tr_b16 v[90:91], v5 offset:25088
  v_mfma_f32_16x16x32_bf16 v[56:59], v[112:115], v[136:139], v[56:59]
  ds_read_b128 v[120:123], v13 offset:16384
  v_mfma_f32_16x16x32_bf16 v[72:75], v[116:119], v[136:139], v[72:75]
  ds_read_b64_tr_b16 v[92:93], v6 offset:24576
  v_mfma_f32_16x16x32_bf16 v[28:31], v[104:107], v[140:143], v[28:31]
  ds_read_b64_tr_b16 v[94:95], v6 offset:25088
  v_mfma_f32_16x16x32_bf16 v[44:47], v[108:111], v[140:143], v[44:47]
  ds_read_b128 v[124:127], v13 offset:18432
  v_mfma_f32_16x16x32_bf16 v[60:63], v[112:115], v[140:143], v[60:63]
  ds_read_b64_tr_b16 v[96:97], v7 offset:24576
  v_mfma_f32_16x16x32_bf16 v[76:79], v[116:119], v[140:143], v[76:79]
  ds_read_b64_tr_b16 v[98:99], v7 offset:25088
  v_mfma_f32_16x16x32_bf16 v[32:35], v[104:107], v[144:147], v[32:35]
  ds_read_b128 v[128:131], v13 offset:20480
  v_mfma_f32_16x16x32_bf16 v[48:51], v[108:111], v[144:147], v[48:51]
  ds_read_b64_tr_b16 v[100:101], v8 offset:24576
  v_mfma_f32_16x16x32_bf16 v[64:67], v[112:115], v[144:147], v[64:67]
  ds_read_b64_tr_b16 v[102:103], v8 offset:25088
  v_mfma_f32_16x16x32_bf16 v[80:83], v[116:119], v[144:147], v[80:83]
  ds_read_b128 v[132:135], v13 offset:22528
  v_mfma_f32_16x16x32_bf16 v[36:39], v[104:107], v[148:151], v[36:39]
  v_mfma_f32_16x16x32_bf16 v[52:55], v[108:111], v[148:151], v[52:55]
  v_mfma_f32_16x16x32_bf16 v[68:71], v[112:115], v[148:151], v[68:71]
  v_mfma_f32_16x16x32_bf16 v[84:87], v[116:119], v[148:151], v[84:87]
  s_waitcnt lgkmcnt(0)
  s_add_u32 m0, s32, 36864
  s_nop 0
  buffer_load_dwordx4 v3, s[12:15], s40 offen lds
  s_add_u32 s40, s40, 8192
  s_add_u32 m0, s32, 37888
  s_nop 0
  buffer_load_dwordx4 v4, s[12:15], s40 offen lds
  s_add_u32 s40, s40, 8192
  s_add_u32 m0, s32, 38912
  s_nop 0
  buffer_load_dwordx4 v3, s[12:15], s40 offen lds
  s_add_u32 s40, s40, 8192
  s_add_u32 m0, s32, 39936
  s_nop 0
  buffer_load_dwordx4 v4, s[12:15], s40 offen lds
  s_add_u32 s40, s40, 8192
  s_lshl_b32 s43, s42, 7
  s_add_u32 s42, s42, 1
  s_cmp_ge_u32 s42, 7
  s_cselect_b32 s42, 0, s42
  s_add_u32 s41, s36, s43
  s_add_u32 m0, s32, 8192
  s_nop 0
  buffer_load_dwordx4 v2, s[8:11], s41 offen sc1 lds
  s_add_u32 m0, s32, 9216
  s_nop 0
  buffer_load_dwordx4 v15, s[8:11], s41 offen sc1 lds
  s_add_u32 s41, s37, s43
  s_add_u32 m0, s32, 10240
  s_nop 0
  buffer_load_dwordx4 v2, s[8:11], s41 offen sc1 lds
  s_add_u32 m0, s32, 11264
  s_nop 0
  buffer_load_dwordx4 v15, s[8:11], s41 offen sc1 lds
  s_add_u32 s41, s38, s43
  s_add_u32 m0, s32, 12288
  s_nop 0
  buffer_load_dwordx4 v2, s[8:11], s41 offen sc1 lds
  s_add_u32 m0, s32, 13312
  s_nop 0
  buffer_load_dwordx4 v15, s[8:11], s41 offen sc1 lds
  s_add_u32 s41, s39, s43
  s_add_u32 m0, s32, 14336
  s_nop 0
  buffer_load_dwordx4 v2, s[8:11], s41 offen sc1 lds
  s_add_u32 m0, s32, 15360
  s_nop 0
  buffer_load_dwordx4 v15, s[8:11], s41 offen sc1 lds
  s_waitcnt vmcnt(24)
  v_mfma_f32_16x16x32_bf16 v[24:27], v[88:91], v[120:123], v[24:27]
  ds_read_b64_tr_b16 v[104:105], v5 offset:28672
  v_mfma_f32_16x16x32_bf16 v[40:43], v[92:95], v[120:123], v[40:43]
  ds_read_b64_tr_b16 v[106:107], v5 offset:29184
  v_mfma_f32_16x16x32_bf16 v[56:59], v[96:99], v[120:123], v[56:59]
  ds_read_b128 v[136:139], v14 offset:16384
  v_mfma_f32_16x16x32_bf16 v[72:75], v[100:103], v[120:123], v[72:75]
  ds_read_b64_tr_b16 v[108:109], v6 offset:28672
  v_mfma_f32_16x16x32_bf16 v[28:31], v[88:91], v[124:127], v[28:31]
  ds_read_b64_tr_b16 v[110:111], v6 offset:29184
  v_mfma_f32_16x16x32_bf16 v[44:47], v[92:95], v[124:127], v[44:47]
  ds_read_b128 v[140:143], v14 offset:18432
  v_mfma_f32_16x16x32_bf16 v[60:63], v[96:99], v[124:127], v[60:63]
  ds_read_b64_tr_b16 v[112:113], v7 offset:28672
  v_mfma_f32_16x16x32_bf16 v[76:79], v[100:103], v[124:127], v[76:79]
  ds_read_b64_tr_b16 v[114:115], v7 offset:29184
  v_mfma_f32_16x16x32_bf16 v[32:35], v[88:91], v[128:131], v[32:35]
  ds_read_b128 v[144:147], v14 offset:20480
  v_mfma_f32_16x16x32_bf16 v[48:51], v[92:95], v[128:131], v[48:51]
  ds_read_b64_tr_b16 v[116:117], v8 offset:28672
  v_mfma_f32_16x16x32_bf16 v[64:67], v[96:99], v[128:131], v[64:67]
  ds_read_b64_tr_b16 v[118:119], v8 offset:29184
  v_mfma_f32_16x16x32_bf16 v[80:83], v[100:103], v[128:131], v[80:83]
  ds_read_b128 v[148:151], v14 offset:22528
  v_mfma_f32_16x16x32_bf16 v[36:39], v[88:91], v[132:135], v[36:39]
  v_mfma_f32_16x16x32_bf16 v[52:55], v[92:95], v[132:135], v[52:55]
  v_mfma_f32_16x16x32_bf16 v[68:71], v[96:99], v[132:135], v[68:71]
  v_mfma_f32_16x16x32_bf16 v[84:87], v[100:103], v[132:135], v[84:87]
  s_waitcnt lgkmcnt(0)
  s_lshl_b32 s40, s50, 16
  s_add_u32 s50, s50, 1
  s_cmp_ge_u32 s50, 7
  s_cselect_b32 s50, 0, s50
  s_add_u32 m0, s32, 24576
  s_nop 0
  buffer_load_dwordx4 v3, s[12:15], s40 offen lds
  s_add_u32 s40, s40, 8192
  s_add_u32 m0, s32, 25600
  s_nop 0
  buffer_load_dwordx4 v4, s[12:15], s40 offen lds
  s_add_u32 s40, s40, 8192
  s_add_u32 m0, s32, 26624
  s_nop 0
  buffer_load_dwordx4 v3, s[12:15], s40 offen lds
  s_add_u32 s40, s40, 8192
  s_add_u32 m0, s32, 27648
  s_nop 0
  buffer_load_dwordx4 v4, s[12:15], s40 offen lds
  s_add_u32 s40, s40, 8192
  s_waitcnt vmcnt(20)
  s_waitcnt vmcnt(16)
  v_mfma_f32_16x16x32_bf16 v[24:27], v[104:107], v[136:139], v[24:27]
  ds_read_b64_tr_b16 v[88:89], v5 offset:32768
  v_mfma_f32_16x16x32_bf16 v[40:43], v[108:111], v[136:139], v[40:43]
  ds_read_b64_tr_b16 v[90:91], v5 offset:33280
  v_mfma_f32_16x16x32_bf16 v[56:59], v[112:115], v[136:139], v[56:59]
  ds_read_b128 v[120:123], v13 offset:0
  v_mfma_f32_16x16x32_bf16 v[72:75], v[116:119], v[136:139], v[72:75]
  ds_read_b64_tr_b16 v[92:93], v6 offset:32768
  v_mfma_f32_16x16x32_bf16 v[28:31], v[104:107], v[140:143], v[28:31]
  ds_read_b64_tr_b16 v[94:95], v6 offset:33280
  v_mfma_f32_16x16x32_bf16 v[44:47], v[108:111], v[140:143], v[44:47]
  ds_read_b128 v[124:127], v13 offset:2048
  v_mfma_f32_16x16x32_bf16 v[60:63], v[112:115], v[140:143], v[60:63]
  ds_read_b64_tr_b16 v[96:97], v7 offset:32768
  v_mfma_f32_16x16x32_bf16 v[76:79], v[116:119], v[140:143], v[76:79]
  ds_read_b64_tr_b16 v[98:99], v7 offset:33280
  v_mfma_f32_16x16x32_bf16 v[32:35], v[104:107], v[144:147], v[32:35]
  ds_read_b128 v[128:131], v13 offset:4096
  v_mfma_f32_16x16x32_bf16 v[48:51], v[108:111], v[144:147], v[48:51]
  ds_read_b64_tr_b16 v[100:101], v8 offset:32768
  v_mfma_f32_16x16x32_bf16 v[64:67], v[112:115], v[144:147], v[64:67]
  ds_read_b64_tr_b16 v[102:103], v8 offset:33280
  v_mfma_f32_16x16x32_bf16 v[80:83], v[116:119], v[144:147], v[80:83]
  ds_read_b128 v[132:135], v13 offset:6144
  v_mfma_f32_16x16x32_bf16 v[36:39], v[104:107], v[148:151], v[36:39]
  v_mfma_f32_16x16x32_bf16 v[52:55], v[108:111], v[148:151], v[52:55]
  v_mfma_f32_16x16x32_bf16 v[68:71], v[112:115], v[148:151], v[68:71]
  v_mfma_f32_16x16x32_bf16 v[84:87], v[116:119], v[148:151], v[84:87]
  s_waitcnt lgkmcnt(0)
  s_add_u32 m0, s32, 28672
  s_nop 0
  buffer_load_dwordx4 v3, s[12:15], s40 offen lds
  s_add_u32 s40, s40, 8192
  s_add_u32 m0, s32, 29696
  s_nop 0
  buffer_load_dwordx4 v4, s[12:15], s40 offen lds
  s_add_u32 s40, s40, 8192
  s_add_u32 m0, s32, 30720
  s_nop 0
  buffer_load_dwordx4 v3, s[12:15], s40 offen lds
  s_add_u32 s40, s40, 8192
  s_add_u32 m0, s32, 31744
  s_nop 0
  buffer_load_dwordx4 v4, s[12:15], s40 offen lds
  s_add_u32 s40, s40, 8192
  s_lshl_b32 s43, s42, 7
  s_add_u32 s42, s42, 1
  s_cmp_ge_u32 s42, 7
  s_cselect_b32 s42, 0, s42
  s_add_u32 s41, s36, s43
  s_add_u32 m0, s32, 16384
  s_nop 0
  buffer_load_dwordx4 v2, s[8:11], s41 offen sc1 lds
  s_add_u32 m0, s32, 17408
  s_nop 0
  buffer_load_dwordx4 v15, s[8:11], s41 offen sc1 lds
  s_add_u32 s41, s37, s43
  s_add_u32 m0, s32, 18432
  s_nop 0
  buffer_load_dwordx4 v2, s[8:11], s41 offen sc1 lds
  s_add_u32 m0, s32, 19456
  s_nop 0
  buffer_load_dwordx4 v15, s[8:11], s41 offen sc1 lds
  s_add_u32 s41, s38, s43
  s_add_u32 m0, s32, 20480
  s_nop 0
  buffer_load_dwordx4 v2, s[8:11], s41 offen sc1 lds
  s_add_u32 m0, s32, 21504
  s_nop 0
  buffer_load_dwordx4 v15, s[8:11], s41 offen sc1 lds
  s_add_u32 s41, s39, s43
  s_add_u32 m0, s32, 22528
  s_nop 0
  buffer_load_dwordx4 v2, s[8:11], s41 offen sc1 lds
  s_add_u32 m0, s32, 23552
  s_nop 0
  buffer_load_dwordx4 v15, s[8:11], s41 offen sc1 lds
  s_waitcnt vmcnt(24)
  v_mfma_f32_16x16x32_bf16 v[24:27], v[88:91], v[120:123], v[24:27]
  ds_read_b64_tr_b16 v[104:105], v5 offset:36864
  v_mfma_f32_16x16x32_bf16 v[40:43], v[92:95], v[120:123], v[40:43]
  ds_read_b64_tr_b16 v[106:107], v5 offset:37376
  v_mfma_f32_16x16x32_bf16 v[56:59], v[96:99], v[120:123], v[56:59]
  ds_read_b128 v[136:139], v14 offset:0
  v_mfma_f32_16x16x32_bf16 v[72:75], v[100:103], v[120:123], v[72:75]
  ds_read_b64_tr_b16 v[108:109], v6 offset:36864
  v_mfma_f32_16x16x32_bf16 v[28:31], v[88:91], v[124:127], v[28:31]
  ds_read_b64_tr_b16 v[110:111], v6 offset:37376
  v_mfma_f32_16x16x32_bf16 v[44:47], v[92:95], v[124:127], v[44:47]
  ds_read_b128 v[140:143], v14 offset:2048
  v_mfma_f32_16x16x32_bf16 v[60:63], v[96:99], v[124:127], v[60:63]
  ds_read_b64_tr_b16 v[112:113], v7 offset:36864
  v_mfma_f32_16x16x32_bf16 v[76:79], v[100:103], v[124:127], v[76:79]
  ds_read_b64_tr_b16 v[114:115], v7 offset:37376
  v_mfma_f32_16x16x32_bf16 v[32:35], v[88:91], v[128:131], v[32:35]
  ds_read_b128 v[144:147], v14 offset:4096
  v_mfma_f32_16x16x32_bf16 v[48:51], v[92:95], v[128:131], v[48:51]
  ds_read_b64_tr_b16 v[116:117], v8 offset:36864
  v_mfma_f32_16x16x32_bf16 v[64:67], v[96:99], v[128:131], v[64:67]
  ds_read_b64_tr_b16 v[118:119], v8 offset:37376
  v_mfma_f32_16x16x32_bf16 v[80:83], v[100:103], v[128:131], v[80:83]
  ds_read_b128 v[148:151], v14 offset:6144
  v_mfma_f32_16x16x32_bf16 v[36:39], v[88:91], v[132:135], v[36:39]
  v_mfma_f32_16x16x32_bf16 v[52:55], v[92:95], v[132:135], v[52:55]
  v_mfma_f32_16x16x32_bf16 v[68:71], v[96:99], v[132:135], v[68:71]
  v_mfma_f32_16x16x32_bf16 v[84:87], v[100:103], v[132:135], v[84:87]
  s_waitcnt lgkmcnt(0)
  s_lshl_b32 s40, s50, 16
  s_add_u32 s50, s50, 1
  s_cmp_ge_u32 s50, 7
  s_cselect_b32 s50, 0, s50
  s_add_u32 m0, s32, 32768
  s_nop 0
  buffer_load_dwordx4 v3, s[12:15], s40 offen lds
  s_add_u32 s40, s40, 8192
  s_add_u32 m0, s32, 33792
  s_nop 0
  buffer_load_dwordx4 v4, s[12:15], s40 offen lds
  s_add_u32 s40, s40, 8192
  s_add_u32 m0, s32, 34816
  s_nop 0
  buffer_load_dwordx4 v3, s[12:15], s40 offen lds
  s_add_u32 s40, s40, 8192
  s_add_u32 m0, s32, 35840
  s_nop 0
  buffer_load_dwordx4 v4, s[12:15], s40 offen lds
  s_add_u32 s40, s40, 8192
  s_waitcnt vmcnt(20)
  s_waitcnt vmcnt(16)
  v_mfma_f32_16x16x32_bf16 v[24:27], v[104:107], v[136:139], v[24:27]
  ds_read_b64_tr_b16 v[88:89], v5 offset:24576
  v_mfma_f32_16x16x32_bf16 v[40:43], v[108:111], v[136:139], v[40:43]
  ds_read_b64_tr_b16 v[90:91], v5 offset:25088
  v_mfma_f32_16x16x32_bf16 v[56:59], v[112:115], v[136:139], v[56:59]
  ds_read_b128 v[120:123], v13 offset:8192
  v_mfma_f32_16x16x32_bf16 v[72:75], v[116:119], v[136:139], v[72:75]
  ds_read_b64_tr_b16 v[92:93], v6 offset:24576
  v_mfma_f32_16x16x32_bf16 v[28:31], v[104:107], v[140:143], v[28:31]
  ds_read_b64_tr_b16 v[94:95], v6 offset:25088
  v_mfma_f32_16x16x32_bf16 v[44:47], v[108:111], v[140:143], v[44:47]
  ds_read_b128 v[124:127], v13 offset:10240
  v_mfma_f32_16x16x32_bf16 v[60:63], v[112:115], v[140:143], v[60:63]
  ds_read_b64_tr_b16 v[96:97], v7 offset:24576
  v_mfma_f32_16x16x32_bf16 v[76:79], v[116:119], v[140:143], v[76:79]
  ds_read_b64_tr_b16 v[98:99], v7 offset:25088
  v_mfma_f32_16x16x32_bf16 v[32:35], v[104:107], v[144:147], v[32:35]
  ds_read_b128 v[128:131], v13 offset:12288
  v_mfma_f32_16x16x32_bf16 v[48:51], v[108:111], v[144:147], v[48:51]
  ds_read_b64_tr_b16 v[100:101], v8 offset:24576
  v_mfma_f32_16x16x32_bf16 v[64:67], v[112:115], v[144:147], v[64:67]
  ds_read_b64_tr_b16 v[102:103], v8 offset:25088
  v_mfma_f32_16x16x32_bf16 v[80:83], v[116:119], v[144:147], v[80:83]
  ds_read_b128 v[132:135], v13 offset:14336
  v_mfma_f32_16x16x32_bf16 v[36:39], v[104:107], v[148:151], v[36:39]
  v_mfma_f32_16x16x32_bf16 v[52:55], v[108:111], v[148:151], v[52:55]
  v_mfma_f32_16x16x32_bf16 v[68:71], v[112:115], v[148:151], v[68:71]
  v_mfma_f32_16x16x32_bf16 v[84:87], v[116:119], v[148:151], v[84:87]
  s_waitcnt lgkmcnt(0)
  s_add_u32 m0, s32, 36864
  s_nop 0
  buffer_load_dwordx4 v3, s[12:15], s40 offen lds
  s_add_u32 s40, s40, 8192
  s_add_u32 m0, s32, 37888
  s_nop 0
  buffer_load_dwordx4 v4, s[12:15], s40 offen lds
  s_add_u32 s40, s40, 8192
  s_add_u32 m0, s32, 38912
  s_nop 0
  buffer_load_dwordx4 v3, s[12:15], s40 offen lds
  s_add_u32 s40, s40, 8192
  s_add_u32 m0, s32, 39936
  s_nop 0
  buffer_load_dwordx4 v4, s[12:15], s40 offen lds
  s_add_u32 s40, s40, 8192
  s_lshl_b32 s43, s42, 7
  s_add_u32 s42, s42, 1
  s_cmp_ge_u32 s42, 7
  s_cselect_b32 s42, 0, s42
  s_add_u32 s41, s36, s43
  s_add_u32 m0, s32, 0
  s_nop 0
  buffer_load_dwordx4 v2, s[8:11], s41 offen sc1 lds
  s_add_u32 m0, s32, 1024
  s_nop 0
  buffer_load_dwordx4 v15, s[8:11], s41 offen sc1 lds
  s_add_u32 s41, s37, s43
  s_add_u32 m0, s32, 2048
  s_nop 0
  buffer_load_dwordx4 v2, s[8:11], s41 offen sc1 lds
  s_add_u32 m0, s32, 3072
  s_nop 0
  buffer_load_dwordx4 v15, s[8:11], s41 offen sc1 lds
  s_add_u32 s41, s38, s43
  s_add_u32 m0, s32, 4096
  s_nop 0
  buffer_load_dwordx4 v2, s[8:11], s41 offen sc1 lds
  s_add_u32 m0, s32, 5120
  s_nop 0
  buffer_load_dwordx4 v15, s[8:11], s41 offen sc1 lds
  s_add_u32 s41, s39, s43
  s_add_u32 m0, s32, 6144
  s_nop 0
  buffer_load_dwordx4 v2, s[8:11], s41 offen sc1 lds
  s_add_u32 m0, s32, 7168
  s_nop 0
  buffer_load_dwordx4 v15, s[8:11], s41 offen sc1 lds
  s_waitcnt vmcnt(24)
  v_mfma_f32_16x16x32_bf16 v[24:27], v[88:91], v[120:123], v[24:27]
  ds_read_b64_tr_b16 v[104:105], v5 offset:28672
  v_mfma_f32_16x16x32_bf16 v[40:43], v[92:95], v[120:123], v[40:43]
  ds_read_b64_tr_b16 v[106:107], v5 offset:29184
  v_mfma_f32_16x16x32_bf16 v[56:59], v[96:99], v[120:123], v[56:59]
  ds_read_b128 v[136:139], v14 offset:8192
  v_mfma_f32_16x16x32_bf16 v[72:75], v[100:103], v[120:123], v[72:75]
  ds_read_b64_tr_b16 v[108:109], v6 offset:28672
  v_mfma_f32_16x16x32_bf16 v[28:31], v[88:91], v[124:127], v[28:31]
  ds_read_b64_tr_b16 v[110:111], v6 offset:29184
  v_mfma_f32_16x16x32_bf16 v[44:47], v[92:95], v[124:127], v[44:47]
  ds_read_b128 v[140:143], v14 offset:10240
  v_mfma_f32_16x16x32_bf16 v[60:63], v[96:99], v[124:127], v[60:63]
  ds_read_b64_tr_b16 v[112:113], v7 offset:28672
  v_mfma_f32_16x16x32_bf16 v[76:79], v[100:103], v[124:127], v[76:79]
  ds_read_b64_tr_b16 v[114:115], v7 offset:29184
  v_mfma_f32_16x16x32_bf16 v[32:35], v[88:91], v[128:131], v[32:35]
  ds_read_b128 v[144:147], v14 offset:12288
  v_mfma_f32_16x16x32_bf16 v[48:51], v[92:95], v[128:131], v[48:51]
  ds_read_b64_tr_b16 v[116:117], v8 offset:28672
  v_mfma_f32_16x16x32_bf16 v[64:67], v[96:99], v[128:131], v[64:67]
  ds_read_b64_tr_b16 v[118:119], v8 offset:29184
  v_mfma_f32_16x16x32_bf16 v[80:83], v[100:103], v[128:131], v[80:83]
  ds_read_b128 v[148:151], v14 offset:14336
  v_mfma_f32_16x16x32_bf16 v[36:39], v[88:91], v[132:135], v[36:39]
  v_mfma_f32_16x16x32_bf16 v[52:55], v[92:95], v[132:135], v[52:55]
  v_mfma_f32_16x16x32_bf16 v[68:71], v[96:99], v[132:135], v[68:71]
  v_mfma_f32_16x16x32_bf16 v[84:87], v[100:103], v[132:135], v[84:87]
  s_waitcnt lgkmcnt(0)
  s_lshl_b32 s40, s50, 16
  s_add_u32 s50, s50, 1
  s_cmp_ge_u32 s50, 7
  s_cselect_b32 s50, 0, s50
  s_add_u32 m0, s32, 24576
  s_nop 0
  buffer_load_dwordx4 v3, s[12:15], s40 offen lds
  s_add_u32 s40, s40, 8192
  s_add_u32 m0, s32, 25600
  s_nop 0
  buffer_load_dwordx4 v4, s[12:15], s40 offen lds
  s_add_u32 s40, s40, 8192
  s_add_u32 m0, s32, 26624
  s_nop 0
  buffer_load_dwordx4 v3, s[12:15], s40 offen lds
  s_add_u32 s40, s40, 8192
  s_add_u32 m0, s32, 27648
  s_nop 0
  buffer_load_dwordx4 v4, s[12:15], s40 offen lds
  s_add_u32 s40, s40, 8192
  s_waitcnt vmcnt(20)
  s_waitcnt vmcnt(16)
  v_mfma_f32_16x16x32_bf16 v[24:27], v[104:107], v[136:139], v[24:27]
  ds_read_b64_tr_b16 v[88:89], v5 offset:32768
  v_mfma_f32_16x16x32_bf16 v[40:43], v[108:111], v[136:139], v[40:43]
  ds_read_b64_tr_b16 v[90:91], v5 offset:33280
  v_mfma_f32_16x16x32_bf16 v[56:59], v[112:115], v[136:139], v[56:59]
  ds_read_b128 v[120:123], v13 offset:16384
  v_mfma_f32_16x16x32_bf16 v[72:75], v[116:119], v[136:139], v[72:75]
  ds_read_b64_tr_b16 v[92:93], v6 offset:32768
  v_mfma_f32_16x16x32_bf16 v[28:31], v[104:107], v[140:143], v[28:31]
  ds_read_b64_tr_b16 v[94:95], v6 offset:33280
  v_mfma_f32_16x16x32_bf16 v[44:47], v[108:111], v[140:143], v[44:47]
  ds_read_b128 v[124:127], v13 offset:18432
  v_mfma_f32_16x16x32_bf16 v[60:63], v[112:115], v[140:143], v[60:63]
  ds_read_b64_tr_b16 v[96:97], v7 offset:32768
  v_mfma_f32_16x16x32_bf16 v[76:79], v[116:119], v[140:143], v[76:79]
  ds_read_b64_tr_b16 v[98:99], v7 offset:33280
  v_mfma_f32_16x16x32_bf16 v[32:35], v[104:107], v[144:147], v[32:35]
  ds_read_b128 v[128:131], v13 offset:20480
  v_mfma_f32_16x16x32_bf16 v[48:51], v[108:111], v[144:147], v[48:51]
  ds_read_b64_tr_b16 v[100:101], v8 offset:32768
  v_mfma_f32_16x16x32_bf16 v[64:67], v[112:115], v[144:147], v[64:67]
  ds_read_b64_tr_b16 v[102:103], v8 offset:33280
  v_mfma_f32_16x16x32_bf16 v[80:83], v[116:119], v[144:147], v[80:83]
  ds_read_b128 v[132:135], v13 offset:22528
  v_mfma_f32_16x16x32_bf16 v[36:39], v[104:107], v[148:151], v[36:39]
  v_mfma_f32_16x16x32_bf16 v[52:55], v[108:111], v[148:151], v[52:55]
  v_mfma_f32_16x16x32_bf16 v[68:71], v[112:115], v[148:151], v[68:71]
  v_mfma_f32_16x16x32_bf16 v[84:87], v[116:119], v[148:151], v[84:87]
  s_waitcnt lgkmcnt(0)
  s_add_u32 m0, s32, 28672
  s_nop 0
  buffer_load_dwordx4 v3, s[12:15], s40 offen lds
  s_add_u32 s40, s40, 8192
  s_add_u32 m0, s32, 29696
  s_nop 0
  buffer_load_dwordx4 v4, s[12:15], s40 offen lds
  s_add_u32 s40, s40, 8192
  s_add_u32 m0, s32, 30720
  s_nop 0
  buffer_load_dwordx4 v3, s[12:15], s40 offen lds
  s_add_u32 s40, s40, 8192
  s_add_u32 m0, s32, 31744
  s_nop 0
  buffer_load_dwordx4 v4, s[12:15], s40 offen lds
  s_add_u32 s40, s40, 8192
  s_waitcnt vmcnt(16)
  v_mfma_f32_16x16x32_bf16 v[24:27], v[88:91], v[120:123], v[24:27]
  ds_read_b64_tr_b16 v[104:105], v5 offset:36864
  v_mfma_f32_16x16x32_bf16 v[40:43], v[92:95], v[120:123], v[40:43]
  ds_read_b64_tr_b16 v[106:107], v5 offset:37376
  v_mfma_f32_16x16x32_bf16 v[56:59], v[96:99], v[120:123], v[56:59]
  ds_read_b128 v[136:139], v14 offset:16384
  v_mfma_f32_16x16x32_bf16 v[72:75], v[100:103], v[120:123], v[72:75]
  ds_read_b64_tr_b16 v[108:109], v6 offset:36864
  v_mfma_f32_16x16x32_bf16 v[28:31], v[88:91], v[124:127], v[28:31]
  ds_read_b64_tr_b16 v[110:111], v6 offset:37376
  v_mfma_f32_16x16x32_bf16 v[44:47], v[92:95], v[124:127], v[44:47]
  ds_read_b128 v[140:143], v14 offset:18432
  v_mfma_f32_16x16x32_bf16 v[60:63], v[96:99], v[124:127], v[60:63]
  ds_read_b64_tr_b16 v[112:113], v7 offset:36864
  v_mfma_f32_16x16x32_bf16 v[76:79], v[100:103], v[124:127], v[76:79]
  ds_read_b64_tr_b16 v[114:115], v7 offset:37376
  v_mfma_f32_16x16x32_bf16 v[32:35], v[88:91], v[128:131], v[32:35]
  ds_read_b128 v[144:147], v14 offset:20480
  v_mfma_f32_16x16x32_bf16 v[48:51], v[92:95], v[128:131], v[48:51]
  ds_read_b64_tr_b16 v[116:117], v8 offset:36864
  v_mfma_f32_16x16x32_bf16 v[64:67], v[96:99], v[128:131], v[64:67]
  ds_read_b64_tr_b16 v[118:119], v8 offset:37376
  v_mfma_f32_16x16x32_bf16 v[80:83], v[100:103], v[128:131], v[80:83]
  ds_read_b128 v[148:151], v14 offset:22528
  v_mfma_f32_16x16x32_bf16 v[36:39], v[88:91], v[132:135], v[36:39]
  v_mfma_f32_16x16x32_bf16 v[52:55], v[92:95], v[132:135], v[52:55]
  v_mfma_f32_16x16x32_bf16 v[68:71], v[96:99], v[132:135], v[68:71]
  v_mfma_f32_16x16x32_bf16 v[84:87], v[100:103], v[132:135], v[84:87]
  s_waitcnt lgkmcnt(0)
  s_add_u32 m0, s32, 8192
  s_nop 0
  buffer_load_dwordx4 v156, s[16:19], 0 offen sc1 lds
  s_add_u32 m0, s32, 9216
  s_nop 0
  buffer_load_dwordx4 v157, s[16:19], 0 offen sc1 lds
  s_waitcnt vmcnt(10)
  s_waitcnt vmcnt(6)
  v_mfma_f32_16x16x32_bf16 v[24:27], v[104:107], v[136:139], v[24:27]
  ds_read_b64_tr_b16 v[88:89], v5 offset:24576
  v_mfma_f32_16x16x32_bf16 v[40:43], v[108:111], v[136:139], v[40:43]
  ds_read_b64_tr_b16 v[90:91], v5 offset:25088
  v_mfma_f32_16x16x32_bf16 v[56:59], v[112:115], v[136:139], v[56:59]
  ds_read_b128 v[120:123], v13 offset:0
  v_mfma_f32_16x16x32_bf16 v[72:75], v[116:119], v[136:139], v[72:75]
  ds_read_b64_tr_b16 v[92:93], v6 offset:24576
  v_mfma_f32_16x16x32_bf16 v[28:31], v[104:107], v[140:143], v[28:31]
  ds_read_b64_tr_b16 v[94:95], v6 offset:25088
  v_mfma_f32_16x16x32_bf16 v[44:47], v[108:111], v[140:143], v[44:47]
  ds_read_b128 v[124:127], v13 offset:2048
  v_mfma_f32_16x16x32_bf16 v[60:63], v[112:115], v[140:143], v[60:63]
  ds_read_b64_tr_b16 v[96:97], v7 offset:24576
  v_mfma_f32_16x16x32_bf16 v[76:79], v[116:119], v[140:143], v[76:79]
  ds_read_b64_tr_b16 v[98:99], v7 offset:25088
  v_mfma_f32_16x16x32_bf16 v[32:35], v[104:107], v[144:147], v[32:35]
  ds_read_b128 v[128:131], v13 offset:4096
  v_mfma_f32_16x16x32_bf16 v[48:51], v[108:111], v[144:147], v[48:51]
  ds_read_b64_tr_b16 v[100:101], v8 offset:24576
  v_mfma_f32_16x16x32_bf16 v[64:67], v[112:115], v[144:147], v[64:67]
  ds_read_b64_tr_b16 v[102:103], v8 offset:25088
  v_mfma_f32_16x16x32_bf16 v[80:83], v[116:119], v[144:147], v[80:83]
  ds_read_b128 v[132:135], v13 offset:6144
  v_mfma_f32_16x16x32_bf16 v[36:39], v[104:107], v[148:151], v[36:39]
  v_mfma_f32_16x16x32_bf16 v[52:55], v[108:111], v[148:151], v[52:55]
  v_mfma_f32_16x16x32_bf16 v[68:71], v[112:115], v[148:151], v[68:71]
  v_mfma_f32_16x16x32_bf16 v[84:87], v[116:119], v[148:151], v[84:87]
  s_waitcnt lgkmcnt(0)
  s_waitcnt vmcnt(2)
  v_mfma_f32_16x16x32_bf16 v[24:27], v[88:91], v[120:123], v[24:27]
  ds_read_b64_tr_b16 v[104:105], v5 offset:28672
  v_mfma_f32_16x16x32_bf16 v[40:43], v[92:95], v[120:123], v[40:43]
  ds_read_b64_tr_b16 v[106:107], v5 offset:29184
  v_mfma_f32_16x16x32_bf16 v[56:59], v[96:99], v[120:123], v[56:59]
  ds_read_b128 v[136:139], v14 offset:0
  v_mfma_f32_16x16x32_bf16 v[72:75], v[100:103], v[120:123], v[72:75]
  ds_read_b64_tr_b16 v[108:109], v6 offset:28672
  v_mfma_f32_16x16x32_bf16 v[28:31], v[88:91], v[124:127], v[28:31]
  ds_read_b64_tr_b16 v[110:111], v6 offset:29184
  v_mfma_f32_16x16x32_bf16 v[44:47], v[92:95], v[124:127], v[44:47]
  ds_read_b128 v[140:143], v14 offset:2048
  v_mfma_f32_16x16x32_bf16 v[60:63], v[96:99], v[124:127], v[60:63]
  ds_read_b64_tr_b16 v[112:113], v7 offset:28672
  v_mfma_f32_16x16x32_bf16 v[76:79], v[100:103], v[124:127], v[76:79]
  ds_read_b64_tr_b16 v[114:115], v7 offset:29184
  v_mfma_f32_16x16x32_bf16 v[32:35], v[88:91], v[128:131], v[32:35]
  ds_read_b128 v[144:147], v14 offset:4096
  v_mfma_f32_16x16x32_bf16 v[48:51], v[92:95], v[128:131], v[48:51]
  ds_read_b64_tr_b16 v[116:117], v8 offset:28672
  v_mfma_f32_16x16x32_bf16 v[64:67], v[96:99], v[128:131], v[64:67]
  ds_read_b64_tr_b16 v[118:119], v8 offset:29184
  v_mfma_f32_16x16x32_bf16 v[80:83], v[100:103], v[128:131], v[80:83]
  ds_read_b128 v[148:151], v14 offset:6144
  v_mfma_f32_16x16x32_bf16 v[36:39], v[88:91], v[132:135], v[36:39]
  v_mfma_f32_16x16x32_bf16 v[52:55], v[92:95], v[132:135], v[52:55]
  v_mfma_f32_16x16x32_bf16 v[68:71], v[96:99], v[132:135], v[68:71]
  v_mfma_f32_16x16x32_bf16 v[84:87], v[100:103], v[132:135], v[84:87]
  s_waitcnt lgkmcnt(0)
  v_mfma_f32_16x16x32_bf16 v[24:27], v[104:107], v[136:139], v[24:27]
  v_mfma_f32_16x16x32_bf16 v[40:43], v[108:111], v[136:139], v[40:43]
  v_mfma_f32_16x16x32_bf16 v[56:59], v[112:115], v[136:139], v[56:59]
  v_mfma_f32_16x16x32_bf16 v[72:75], v[116:119], v[136:139], v[72:75]
  v_mfma_f32_16x16x32_bf16 v[28:31], v[104:107], v[140:143], v[28:31]
  v_mfma_f32_16x16x32_bf16 v[44:47], v[108:111], v[140:143], v[44:47]
  v_mfma_f32_16x16x32_bf16 v[60:63], v[112:115], v[140:143], v[60:63]
  v_mfma_f32_16x16x32_bf16 v[76:79], v[116:119], v[140:143], v[76:79]
  v_mfma_f32_16x16x32_bf16 v[32:35], v[104:107], v[144:147], v[32:35]
  v_mfma_f32_16x16x32_bf16 v[48:51], v[108:111], v[144:147], v[48:51]
  v_mfma_f32_16x16x32_bf16 v[64:67], v[112:115], v[144:147], v[64:67]
  v_mfma_f32_16x16x32_bf16 v[80:83], v[116:119], v[144:147], v[80:83]
  v_mfma_f32_16x16x32_bf16 v[36:39], v[104:107], v[148:151], v[36:39]
  v_mfma_f32_16x16x32_bf16 v[52:55], v[108:111], v[148:151], v[52:55]
  v_mfma_f32_16x16x32_bf16 v[68:71], v[112:115], v[148:151], v[68:71]
  v_mfma_f32_16x16x32_bf16 v[84:87], v[116:119], v[148:151], v[84:87]
  v_and_b32 v12, 15, v1
  v_lshlrev_b32 v12, 7, v12
  v_lshrrev_b32 v11, 4, v1
  v_lshl_add_u32 v12, v11, 3, v12
  v_add_u32 v12, s32, v12
  v_and_b32 v158, 15, v1
  v_mul_u32_u24 v158, 144, v158
  v_lshl_add_u32 v158, v11, 3, v158
  v_add_u32 v158, s32, v158
  v_lshrrev_b32 v159, 3, v1
  v_mul_u32_u24 v159, 144, v159
  v_and_b32 v10, 7, v1
  v_lshl_add_u32 v159, v10, 4, v159
  v_add_u32 v159, s32, v159
  s_waitcnt vmcnt(0)
  ds_read_b64 v[16:17], v12 offset:8192
  ds_read_b64 v[18:19], v12 offset:8224
  ds_read_b64 v[20:21], v12 offset:8256
  ds_read_b64 v[22:23], v12 offset:8288
  v_lshlrev_b32 v10, 4, v1
  v_add_u32 v11, s32, v10
  s_nop 7
  s_waitcnt lgkmcnt(0)
  ds_write_b128 v11, v[28:31] offset:0
  ds_write_b128 v11, v[44:47] offset:1024
  ds_write_b128 v11, v[60:63] offset:2048
  ds_write_b128 v11, v[76:79] offset:3072
  ds_write_b128 v11, v[32:35] offset:4096
  ds_write_b128 v11, v[48:51] offset:5120
  ds_write_b128 v11, v[64:67] offset:6144
  ds_write_b128 v11, v[80:83] offset:7168
  ds_write_b128 v11, v[36:39] offset:8192
  ds_write_b128 v11, v[52:55] offset:9216
  ds_write_b128 v11, v[68:71] offset:10240
  ds_write_b128 v11, v[84:87] offset:11264
  v_lshlrev_b32 v136, 16, v16
  v_and_b32 v137, 0xffff0000, v16
  v_lshlrev_b32 v138, 16, v17
  v_and_b32 v139, 0xffff0000, v17
  v_lshlrev_b32 v140, 16, v18
  v_and_b32 v141, 0xffff0000, v18
  v_lshlrev_b32 v142, 16, v19
  v_and_b32 v143, 0xffff0000, v19
  v_lshlrev_b32 v144, 16, v20
  v_and_b32 v145, 0xffff0000, v20
  v_lshlrev_b32 v146, 16, v21
  v_and_b32 v147, 0xffff0000, v21
  v_lshlrev_b32 v148, 16, v22
  v_and_b32 v149, 0xffff0000, v22
  v_lshlrev_b32 v150, 16, v23
  v_and_b32 v151, 0xffff0000, v23
  v_add_f32 v136, v136, v24
  v_add_f32 v137, v137, v25
  v_add_f32 v138, v138, v26
  v_add_f32 v139, v139, v27
  v_add_f32 v140, v140, v40
  v_add_f32 v141, v141, v41
  v_add_f32 v142, v142, v42
  v_add_f32 v143, v143, v43
  v_add_f32 v144, v144, v56
  v_add_f32 v145, v145, v57
  v_add_f32 v146, v146, v58
  v_add_f32 v147, v147, v59
  v_add_f32 v148, v148, v72
  v_add_f32 v149, v149, v73
  v_add_f32 v150, v150, v74
  v_add_f32 v151, v151, v75
  s_waitcnt lgkmcnt(0)
  s_barrier
  s_sub_u32 s3, s28, 1
  s_and_b32 s3, s3, 3
  s_mul_i32 s3, s3, 40960
  v_add_u32 v11, s3, v10
  ds_read_b128 v[88:91], v11 offset:0
  ds_read_b128 v[92:95], v11 offset:1024
  ds_read_b128 v[96:99], v11 offset:2048
  ds_read_b128 v[100:103], v11 offset:3072
  s_sub_u32 s3, s28, 2
  s_and_b32 s3, s3, 3
  s_mul_i32 s3, s3, 40960
  v_add_u32 v11, s3, v10
  ds_read_b128 v[104:107], v11 offset:4096
  ds_read_b128 v[108:111], v11 offset:5120
  ds_read_b128 v[112:115], v11 offset:6144
  ds_read_b128 v[116:119], v11 offset:7168
  s_sub_u32 s3, s28, 3
  s_and_b32 s3, s3, 3
  s_mul_i32 s3, s3, 40960
  v_add_u32 v11, s3, v10
  ds_read_b128 v[120:123], v11 offset:8192
  ds_read_b128 v[124:127], v11 offset:9216
  ds_read_b128 v[128:131], v11 offset:10240
  ds_read_b128 v[132:135], v11 offset:11264
  s_waitcnt lgkmcnt(8)
  v_add_f32 v136, v136, v88
  v_add_f32 v137, v137, v89
  v_add_f32 v138, v138, v90
  v_add_f32 v139, v139, v91
  v_add_f32 v140, v140, v92
  v_add_f32 v141, v141, v93
  v_add_f32 v142, v142, v94
  v_add_f32 v143, v143, v95
  v_add_f32 v144, v144, v96
  v_add_f32 v145, v145, v97
  v_add_f32 v146, v146, v98
  v_add_f32 v147, v147, v99
  v_add_f32 v148, v148, v100
  v_add_f32 v149, v149, v101
  v_add_f32 v150, v150, v102
  v_add_f32 v151, v151, v103
  s_waitcnt lgkmcnt(4)
  v_add_f32 v136, v136, v104
  v_add_f32 v137, v137, v105
  v_add_f32 v138, v138, v106
  v_add_f32 v139, v139, v107
  v_add_f32 v140, v140, v108
  v_add_f32 v141, v141, v109
  v_add_f32 v142, v142, v110
  v_add_f32 v143, v143, v111
  v_add_f32 v144, v144, v112
  v_add_f32 v145, v145, v113
  v_add_f32 v146, v146, v114
  v_add_f32 v147, v147, v115
  v_add_f32 v148, v148, v116
  v_add_f32 v149, v149, v117
  v_add_f32 v150, v150, v118
  v_add_f32 v151, v151, v119
  s_waitcnt lgkmcnt(0)
  v_add_f32 v136, v136, v120
  v_add_f32 v137, v137, v121
  v_add_f32 v138, v138, v122
  v_add_f32 v139, v139, v123
  v_add_f32 v140, v140, v124
  v_add_f32 v141, v141, v125
  v_add_f32 v142, v142, v126
  v_add_f32 v143, v143, v127
  v_add_f32 v144, v144, v128
  v_add_f32 v145, v145, v129
  v_add_f32 v146, v146, v130
  v_add_f32 v147, v147, v131
  v_add_f32 v148, v148, v132
  v_add_f32 v149, v149, v133
  v_add_f32 v150, v150, v134
  v_add_f32 v151, v151, v135
  v_cvt_pk_bf16_f32 v88, v136, v137
  v_cvt_pk_bf16_f32 v89, v138, v139
  v_cvt_pk_bf16_f32 v90, v140, v141
  v_cvt_pk_bf16_f32 v91, v142, v143
  v_cvt_pk_bf16_f32 v92, v144, v145
  v_cvt_pk_bf16_f32 v93, v146, v147
  v_cvt_pk_bf16_f32 v94, v148, v149
  v_cvt_pk_bf16_f32 v95, v150, v151
  ds_write_b64 v158, v[88:89] offset:12288
  ds_write_b64 v158, v[90:91] offset:12320
  ds_write_b64 v158, v[92:93] offset:12352
  ds_write_b64 v158, v[94:95] offset:12384
  s_waitcnt lgkmcnt(0)
  ds_read_b128 v[136:139], v159 offset:12288
  ds_read_b128 v[140:143], v159 offset:13440
  s_waitcnt lgkmcnt(1)
  buffer_store_dwordx4 v[136:139], v156, s[20:23], 0 offen
  s_waitcnt lgkmcnt(0)
  buffer_store_dwordx4 v[140:143], v157, s[20:23], 0 offen
k4_kernel_end:
  s_endpgm

code_end:
.section .rodata,"a"
.p2align 6
.amdhsa_kernel sequential_preLN__sliding_local_dilated__glu_gated_geglu__prompt_kernel
  .amdhsa_next_free_vgpr 256
  .amdhsa_next_free_sgpr 96
  .amdhsa_accum_offset 256
  .amdhsa_group_segment_fixed_size 0
  .amdhsa_kernarg_size 80
  .amdhsa_user_sgpr_count 2
  .amdhsa_user_sgpr_kernarg_segment_ptr 1
  .amdhsa_system_sgpr_workgroup_id_x 1
.end_amdhsa_kernel
```
